```python
import torch

def _softmax(x, axis=-1):
    return torch.softmax(x, dim=axis)
def _gelu(x):
    return torch.nn.functional.gelu(x, approximate="tanh")
def _silu(x):
    return torch.nn.functional.silu(x)
def _sigmoid(x):
    return torch.sigmoid(x)
def _layernorm(x, axis=-1, eps=1e-5):
    m = x.mean(dim=axis, keepdim=True)
    v = x.var(dim=axis, keepdim=True, unbiased=False)
    return (x - m) / torch.sqrt(v + eps)
def _scatter_add(tgt, idx, src, axis=0):
    return tgt.clone().index_add_(axis, idx, src)
def _segment_sum(src, seg, n):
    out = torch.zeros((n,) + src.shape[1:], dtype=src.dtype)
    return out.index_add_(0, seg, src)
def _pad(x, pw):
    flat = tuple(v for pair in reversed(pw) for v in pair)
    return torch.nn.functional.pad(x, flat)

kernel_name = 'concat_heads__softmax_full_mha__mha_block__prompt'

def setup_inputs():

    _w = (lambda a: (lambda t: t.to(torch.bfloat16) if t.is_floating_point() else t)(torch.as_tensor(a)))
    def _A_setup():
        B, S, D = 1, 2048, 1024
        return {
            "x": _w((lambda *s: torch.randn(*s, dtype=torch.bfloat16) * 0.2)(B, S, D)),
            "wqkv": _w((lambda *s: torch.randn(*s, dtype=torch.bfloat16) * 0.2)(D, 3 * D)),
            "wo": _w((lambda *s: torch.randn(*s, dtype=torch.bfloat16) * 0.05)(D, D)),
        }
    _A_in = _A_setup()

    def _B_setup():
        B, S, D, H = 1, 2048, 1024, 32
        return {
            "x": _w((lambda *s: torch.randn(*s, dtype=torch.bfloat16) * 0.2)(B, S, D)),
            "wqkv": _w((lambda *s: torch.randn(*s, dtype=torch.bfloat16) * 0.2)(D, 3 * D)),
            "wo": _w((lambda *s: torch.randn(*s, dtype=torch.bfloat16) * 0.05)(D, D)),
        }
    _B_in = _B_setup()

    return {
        "A_x": _A_in["x"],
        "A_wqkv": _A_in["wqkv"],
        "A_wo": _A_in["wo"],
        "B_x": _B_in["x"],
        "B_wqkv": _B_in["wqkv"],
        "B_wo": _B_in["wo"],
    }

def reference(A_x, A_wqkv, A_wo, B_x, B_wqkv, B_wo):
    def _A_ref(x, wqkv, wo):
        B, S, D = x.shape
        H = 32; Dh = D // H
        qkv = (lambda x, *d: x.permute(*d))((x @ wqkv).reshape(B, S, 3, H, Dh), 2, 0, 3, 1, 4)
        q, k, v = qkv[0], qkv[1], qkv[2]
        scale = Dh ** -0.5
        scores = torch.einsum("bhqd,bhkd->bhqk", q, k) * scale
        p = _softmax(scores, axis=-1)
        o = torch.einsum("bhqk,bhkd->bhqd", p, v)
        return (lambda x, *d: x.permute(*d))(o, 0, 2, 1, 3).reshape(B, S, D) @ wo

    def _B_ref(x, wqkv, wo):
        B, S, D = x.shape
        H = 32
        Dh = D // H
        qkv = (lambda x, *d: x.permute(*d))((x @ wqkv).reshape(B, S, 3, H, Dh), 2, 0, 3, 1, 4)
        q, k, v = qkv[0], qkv[1], qkv[2]
        scores = torch.einsum("bhqd,bhkd->bhqk", q, k) * (Dh ** -0.5)
        p = _softmax(scores, axis=-1)
        o = torch.einsum("bhqk,bhkd->bhqd", p, v)
        return (lambda x, *d: x.permute(*d))(o, 0, 2, 1, 3).reshape(B, S, D) @ wo

    a = _A_ref(A_x, A_wqkv, A_wo)
    b = _B_ref(B_x, B_wqkv, B_wo)
    return torch.concatenate([a, b], axis=-1)
```

```asm
; @launch grid=(256,1,1) block=(768,1,1) lds=163840
.amdgcn_target "amdgcn-amd-amdhsa--gfx950"
.text
.globl concat_heads__softmax_full_mha__mha_block__prompt_kernel
.p2align 8
.type concat_heads__softmax_full_mha__mha_block__prompt_kernel,@function
concat_heads__softmax_full_mha__mha_block__prompt_kernel:
    s_cmp_ge_u32 s2, 256
    s_cbranch_scc1 L_end
    s_load_dwordx4 s[4:7], s[0:1], 0
    s_load_dwordx4 s[8:11], s[0:1], 24
    s_load_dwordx2 s[12:13], s[0:1], 64
    s_load_dwordx2 s[52:53], s[0:1], 16
    s_load_dwordx2 s[54:55], s[0:1], 40
    s_load_dwordx4 s[56:59], s[0:1], 48
    v_lshrrev_b32 v1, 6, v0
    v_and_b32 v0, 63, v0
    v_readfirstlane_b32 s20, v1
    s_and_b32 s14, s2, 7
    s_lshr_b32 s15, s2, 3
    s_lshr_b32 s16, s14, 2
    s_and_b32 s17, s15, 7
    s_and_b32 s18, s14, 3
    s_lshl_b32 s18, s18, 2
    s_lshr_b32 s19, s15, 3
    s_add_u32 s19, s19, 0
    s_and_b32 s19, s19, 3
    s_add_u32 s18, s18, s19
    s_xor_b32 s18, s18, 0
    s_cmp_lt_u32 s20, 8
    s_cbranch_scc1 L_compute
L_loader:
    s_setprio 3
    s_sub_u32 s21, s20, 8
    v_lshrrev_b32 v1, 3, v0
    v_and_b32 v2, 7, v0
    v_lshrrev_b32 v3, 4, v0
    v_xor_b32 v4, v2, v3
    v_xor_b32 v5, 4, v4
    s_lshl_b32 s19, s21, 6
    v_add_u32 v6, s19, v1
    v_lshlrev_b32 v6, 11, v6
    v_lshl_add_u32 v8, v4, 4, v6
    v_lshl_add_u32 v9, v5, 4, v6
    v_add_u32 v9, 16384, v9
    v_add_u32 v10, 32768, v8
    v_add_u32 v11, 32768, v9
    v_add_u32 v12, 65536, v8
    v_add_u32 v13, 65536, v9
    v_add_u32 v14, 98304, v8
    v_add_u32 v15, 98304, v9
    v_and_b32 v4, 1, v3
    v_lshlrev_b32 v4, 1, v4
    v_xor_b32 v4, v2, v4
    s_and_b32 s19, s21, 1
    s_lshl_b32 s19, s19, 2
    v_xor_b32 v4, s19, v4
    s_lshl_b32 s19, s21, 3
    v_add_u32 v6, s19, v1
    v_mul_u32_u24 v6, 6144, v6
    v_lshl_add_u32 v16, v4, 4, v6
    v_add_u32 v17, 2048, v16
    v_add_u32 v18, 4096, v16
    s_mov_b32 s40, 0
    s_mov_b32 s41, 0
    s_lshl_b32 s19, s21, 10
    s_add_u32 s42, s19, 98304
    s_add_u32 s44, s42, 61440
    s_lshl_b32 s43, s21, 13
    s_add_u32 s45, s43, 98304
    s_waitcnt lgkmcnt(0)
    s_cmp_eq_u32 s16, 0
    s_cselect_b32 s24, s4, s8
    s_cselect_b32 s25, s5, s9
    s_cselect_b32 s28, s6, s10
    s_cselect_b32 s29, s7, s11
    s_cselect_b32 s52, s52, s54
    s_cselect_b32 s53, s53, s55
    s_lshl_b32 s19, s17, 19
    s_add_u32 s24, s24, s19
    s_addc_u32 s25, s25, 0
    s_mov_b32 s26, 524288
    s_mov_b32 s27, 0x20000
    s_lshl_b32 s19, s18, 7
    s_add_u32 s28, s28, s19
    s_addc_u32 s29, s29, 0
    s_sub_u32 s30, 6291456, s19
    s_mov_b32 s31, 0x20000
    s_mov_b32 s32, s12
    s_mov_b32 s33, s13
    s_mov_b32 s34, 34603008
    s_mov_b32 s35, 0x20000
    s_add_u32 m0, s42, 0
    s_nop 0
    buffer_load_dwordx4 v16, s[28:31], s41 offen lds
    s_add_u32 m0, s42, 4096
    s_nop 0
    buffer_load_dwordx4 v17, s[28:31], s41 offen lds
    s_add_u32 m0, s42, 8192
    s_nop 0
    buffer_load_dwordx4 v18, s[28:31], s41 offen lds
    s_add_u32 s41, s41, 196608
    s_add_u32 s42, s42, 12288
    s_sub_u32 s19, s42, 61440
    s_cmp_ge_u32 s42, s44
    s_cselect_b32 s42, s19, s42
    s_add_u32 m0, s43, 0
    s_nop 0
    buffer_load_dwordx4 v8, s[24:27], s40 offen lds
    s_add_u32 m0, s43, 1024
    s_nop 0
    buffer_load_dwordx4 v9, s[24:27], s40 offen lds
    s_add_u32 m0, s43, 2048
    s_nop 0
    buffer_load_dwordx4 v10, s[24:27], s40 offen lds
    s_add_u32 m0, s43, 3072
    s_nop 0
    buffer_load_dwordx4 v11, s[24:27], s40 offen lds
    s_add_u32 m0, s43, 4096
    s_nop 0
    buffer_load_dwordx4 v12, s[24:27], s40 offen lds
    s_add_u32 m0, s43, 5120
    s_nop 0
    buffer_load_dwordx4 v13, s[24:27], s40 offen lds
    s_add_u32 m0, s43, 6144
    s_nop 0
    buffer_load_dwordx4 v14, s[24:27], s40 offen lds
    s_add_u32 m0, s43, 7168
    s_nop 0
    buffer_load_dwordx4 v15, s[24:27], s40 offen lds
    s_add_u32 s40, s40, 128
    s_add_u32 s43, s43, 32768
    s_sub_u32 s19, s43, 98304
    s_cmp_ge_u32 s43, s45
    s_cselect_b32 s43, s19, s43
    s_add_u32 m0, s42, 0
    s_nop 0
    buffer_load_dwordx4 v16, s[28:31], s41 offen lds
    s_add_u32 m0, s42, 4096
    s_nop 0
    buffer_load_dwordx4 v17, s[28:31], s41 offen lds
    s_add_u32 m0, s42, 8192
    s_nop 0
    buffer_load_dwordx4 v18, s[28:31], s41 offen lds
    s_add_u32 s41, s41, 196608
    s_add_u32 s42, s42, 12288
    s_sub_u32 s19, s42, 61440
    s_cmp_ge_u32 s42, s44
    s_cselect_b32 s42, s19, s42
    s_add_u32 m0, s42, 0
    s_nop 0
    buffer_load_dwordx4 v16, s[28:31], s41 offen lds
    s_add_u32 m0, s42, 4096
    s_nop 0
    buffer_load_dwordx4 v17, s[28:31], s41 offen lds
    s_add_u32 m0, s42, 8192
    s_nop 0
    buffer_load_dwordx4 v18, s[28:31], s41 offen lds
    s_add_u32 s41, s41, 196608
    s_add_u32 s42, s42, 12288
    s_sub_u32 s19, s42, 61440
    s_cmp_ge_u32 s42, s44
    s_cselect_b32 s42, s19, s42
    s_add_u32 m0, s43, 0
    s_nop 0
    buffer_load_dwordx4 v8, s[24:27], s40 offen lds
    s_add_u32 m0, s43, 1024
    s_nop 0
    buffer_load_dwordx4 v9, s[24:27], s40 offen lds
    s_add_u32 m0, s43, 2048
    s_nop 0
    buffer_load_dwordx4 v10, s[24:27], s40 offen lds
    s_add_u32 m0, s43, 3072
    s_nop 0
    buffer_load_dwordx4 v11, s[24:27], s40 offen lds
    s_add_u32 m0, s43, 4096
    s_nop 0
    buffer_load_dwordx4 v12, s[24:27], s40 offen lds
    s_add_u32 m0, s43, 5120
    s_nop 0
    buffer_load_dwordx4 v13, s[24:27], s40 offen lds
    s_add_u32 m0, s43, 6144
    s_nop 0
    buffer_load_dwordx4 v14, s[24:27], s40 offen lds
    s_add_u32 m0, s43, 7168
    s_nop 0
    buffer_load_dwordx4 v15, s[24:27], s40 offen lds
    s_add_u32 s40, s40, 128
    s_add_u32 s43, s43, 32768
    s_sub_u32 s19, s43, 98304
    s_cmp_ge_u32 s43, s45
    s_cselect_b32 s43, s19, s43
    s_add_u32 m0, s42, 0
    s_nop 0
    buffer_load_dwordx4 v16, s[28:31], s41 offen lds
    s_add_u32 m0, s42, 4096
    s_nop 0
    buffer_load_dwordx4 v17, s[28:31], s41 offen lds
    s_add_u32 m0, s42, 8192
    s_nop 0
    buffer_load_dwordx4 v18, s[28:31], s41 offen lds
    s_add_u32 s41, s41, 196608
    s_add_u32 s42, s42, 12288
    s_sub_u32 s19, s42, 61440
    s_cmp_ge_u32 s42, s44
    s_cselect_b32 s42, s19, s42
    s_mov_b32 s46, 14
L_lg_loop:
    s_waitcnt vmcnt(14)
    s_barrier
    s_add_u32 m0, s42, 0
    s_nop 0
    buffer_load_dwordx4 v16, s[28:31], s41 offen lds
    s_add_u32 m0, s42, 4096
    s_nop 0
    buffer_load_dwordx4 v17, s[28:31], s41 offen lds
    s_add_u32 m0, s42, 8192
    s_nop 0
    buffer_load_dwordx4 v18, s[28:31], s41 offen lds
    s_add_u32 s41, s41, 196608
    s_add_u32 s42, s42, 12288
    s_sub_u32 s19, s42, 61440
    s_cmp_ge_u32 s42, s44
    s_cselect_b32 s42, s19, s42
    s_add_u32 m0, s43, 0
    s_nop 0
    buffer_load_dwordx4 v8, s[24:27], s40 offen lds
    s_add_u32 m0, s43, 1024
    s_nop 0
    buffer_load_dwordx4 v9, s[24:27], s40 offen lds
    s_add_u32 m0, s43, 2048
    s_nop 0
    buffer_load_dwordx4 v10, s[24:27], s40 offen lds
    s_add_u32 m0, s43, 3072
    s_nop 0
    buffer_load_dwordx4 v11, s[24:27], s40 offen lds
    s_add_u32 m0, s43, 4096
    s_nop 0
    buffer_load_dwordx4 v12, s[24:27], s40 offen lds
    s_add_u32 m0, s43, 5120
    s_nop 0
    buffer_load_dwordx4 v13, s[24:27], s40 offen lds
    s_add_u32 m0, s43, 6144
    s_nop 0
    buffer_load_dwordx4 v14, s[24:27], s40 offen lds
    s_add_u32 m0, s43, 7168
    s_nop 0
    buffer_load_dwordx4 v15, s[24:27], s40 offen lds
    s_add_u32 s40, s40, 128
    s_add_u32 s43, s43, 32768
    s_sub_u32 s19, s43, 98304
    s_cmp_ge_u32 s43, s45
    s_cselect_b32 s43, s19, s43
    s_waitcnt vmcnt(14)
    s_barrier
    s_add_u32 m0, s42, 0
    s_nop 0
    buffer_load_dwordx4 v16, s[28:31], s41 offen lds
    s_add_u32 m0, s42, 4096
    s_nop 0
    buffer_load_dwordx4 v17, s[28:31], s41 offen lds
    s_add_u32 m0, s42, 8192
    s_nop 0
    buffer_load_dwordx4 v18, s[28:31], s41 offen lds
    s_add_u32 s41, s41, 196608
    s_add_u32 s42, s42, 12288
    s_sub_u32 s19, s42, 61440
    s_cmp_ge_u32 s42, s44
    s_cselect_b32 s42, s19, s42
    s_sub_u32 s46, s46, 1
    s_cmp_lg_u32 s46, 0
    s_cbranch_scc1 L_lg_loop
    s_waitcnt vmcnt(14)
    s_barrier
    s_waitcnt vmcnt(3)
    s_barrier
    s_waitcnt vmcnt(0)
    s_barrier
    s_branch L_loader2
L_compute:
    s_and_b32 s21, s20, 3
    s_lshr_b32 s22, s20, 2
    v_and_b32 v1, 15, v0
    v_lshrrev_b32 v2, 4, v0
    v_lshrrev_b32 v3, 1, v1
    v_xor_b32 v3, v3, v2
    v_lshlrev_b32 v3, 4, v3
    v_lshl_add_u32 v4, v1, 7, v3
    s_lshl_b32 s19, s21, 13
    v_add_u32 v4, s19, v4
    v_xor_b32 v5, 64, v4
    v_bfe_u32 v9, v0, 2, 2
    v_lshl_add_u32 v10, v2, 3, v9
    v_lshlrev_b32 v10, 7, v10
    v_bfe_u32 v11, v0, 3, 2
    s_lshl_b32 s19, s22, 1
    v_xor_b32 v11, s19, v11
    v_lshl_add_u32 v10, v11, 5, v10
    v_and_b32 v12, 3, v0
    v_lshl_add_u32 v10, v12, 3, v10
    v_add_u32 v6, 98304, v10
    v_xor_b32 v7, 32, v6
    v_mov_b32 v14, 0
    v_mov_b32 v15, 1
    s_cmp_lg_u32 s20, 0
    s_cbranch_scc1 L_noreset
    s_lshl_b32 s36, s16, 4
    s_add_u32 s36, s36, s18
    s_lshl_b32 s36, s36, 3
    s_add_u32 s36, s36, s17
    s_lshl_b32 s36, s36, 7
    s_add_u32 s36, s36, 33554432
    v_lshl_add_u32 v13, v0, 2, s36
    s_waitcnt lgkmcnt(0)
    s_mov_b64 exec, 0xffff
    global_store_dword v13, v14, s[12:13] sc1
    s_mov_b64 exec, -1
L_noreset:
    s_cmp_lg_u32 s20, 1
    s_cbranch_scc1 L_nocw
    s_getpc_b64 s[36:37]
L_cwb:
    v_lshlrev_b32 v157, 7, v0
    v_add_u32 v158, 8192, v157
    global_load_dword v159, v157, s[36:37]
    v_min_u32 v158, L_end-L_cwb, v158
    global_load_dword v160, v158, s[36:37]
L_nocw:
    v_mov_b32 v56, 0
    v_mov_b32 v57, 0
    v_mov_b32 v58, 0
    v_mov_b32 v59, 0
    v_mov_b32 v60, 0
    v_mov_b32 v61, 0
    v_mov_b32 v62, 0
    v_mov_b32 v63, 0
    v_mov_b32 v64, 0
    v_mov_b32 v65, 0
    v_mov_b32 v66, 0
    v_mov_b32 v67, 0
    v_mov_b32 v68, 0
    v_mov_b32 v69, 0
    v_mov_b32 v70, 0
    v_mov_b32 v71, 0
    v_mov_b32 v72, 0
    v_mov_b32 v73, 0
    v_mov_b32 v74, 0
    v_mov_b32 v75, 0
    v_mov_b32 v76, 0
    v_mov_b32 v77, 0
    v_mov_b32 v78, 0
    v_mov_b32 v79, 0
    v_mov_b32 v80, 0
    v_mov_b32 v81, 0
    v_mov_b32 v82, 0
    v_mov_b32 v83, 0
    v_mov_b32 v84, 0
    v_mov_b32 v85, 0
    v_mov_b32 v86, 0
    v_mov_b32 v87, 0
    v_mov_b32 v88, 0
    v_mov_b32 v89, 0
    v_mov_b32 v90, 0
    v_mov_b32 v91, 0
    v_mov_b32 v92, 0
    v_mov_b32 v93, 0
    v_mov_b32 v94, 0
    v_mov_b32 v95, 0
    v_mov_b32 v96, 0
    v_mov_b32 v97, 0
    v_mov_b32 v98, 0
    v_mov_b32 v99, 0
    v_mov_b32 v100, 0
    v_mov_b32 v101, 0
    v_mov_b32 v102, 0
    v_mov_b32 v103, 0
    v_mov_b32 v104, 0
    v_mov_b32 v105, 0
    v_mov_b32 v106, 0
    v_mov_b32 v107, 0
    v_mov_b32 v108, 0
    v_mov_b32 v109, 0
    v_mov_b32 v110, 0
    v_mov_b32 v111, 0
    v_mov_b32 v112, 0
    v_mov_b32 v113, 0
    v_mov_b32 v114, 0
    v_mov_b32 v115, 0
    v_mov_b32 v116, 0
    v_mov_b32 v117, 0
    v_mov_b32 v118, 0
    v_mov_b32 v119, 0
    v_mov_b32 v120, 0
    v_mov_b32 v121, 0
    v_mov_b32 v122, 0
    v_mov_b32 v123, 0
    v_mov_b32 v124, 0
    v_mov_b32 v125, 0
    v_mov_b32 v126, 0
    v_mov_b32 v127, 0
    v_mov_b32 v128, 0
    v_mov_b32 v129, 0
    v_mov_b32 v130, 0
    v_mov_b32 v131, 0
    v_mov_b32 v132, 0
    v_mov_b32 v133, 0
    v_mov_b32 v134, 0
    v_mov_b32 v135, 0
    v_mov_b32 v136, 0
    v_mov_b32 v137, 0
    v_mov_b32 v138, 0
    v_mov_b32 v139, 0
    v_mov_b32 v140, 0
    v_mov_b32 v141, 0
    v_mov_b32 v142, 0
    v_mov_b32 v143, 0
    v_mov_b32 v144, 0
    v_mov_b32 v145, 0
    v_mov_b32 v146, 0
    v_mov_b32 v147, 0
    v_mov_b32 v148, 0
    v_mov_b32 v149, 0
    v_mov_b32 v150, 0
    v_mov_b32 v151, 0
    s_waitcnt lgkmcnt(0)
    s_cmp_eq_u32 s16, 0
    s_cselect_b32 s76, s52, s54
    s_cselect_b32 s77, s53, s55
    s_lshr_b32 s19, s15, 2
    s_lshl_b32 s19, s19, 8
    s_add_u32 s76, s76, s19
    s_addc_u32 s77, s77, 0
    s_sub_u32 s78, 2097152, s19
    s_mov_b32 s79, 0x20000
    s_add_u32 s95, s14, 1
    s_and_b32 s95, s95, 3
    s_lshl_b32 s95, s95, 19
    s_add_u32 s94, s95, 524288
    s_and_b32 s94, s94, 2097151
    s_lshl_b32 s90, s21, 11
    s_add_u32 s90, s90, 49152
    s_lshr_b32 s19, s21, 1
    s_lshl_b32 s19, s19, 6
    s_and_b32 s39, s21, 1
    s_lshl_b32 s39, s39, 4
    s_add_u32 s19, s19, s39
    v_lshrrev_b32 v8, 3, v0
    v_add_u32 v8, s19, v8
    v_lshlrev_b32 v8, 11, v8
    v_and_b32 v9, 7, v0
    v_bfe_u32 v10, v0, 4, 1
    v_lshlrev_b32 v10, 1, v10
    v_xor_b32 v9, v9, v10
    v_lshl_add_u32 v165, v9, 4, v8
    s_mov_b32 s32, s12
    s_mov_b32 s33, s13
    s_mov_b32 s34, 34603008
    s_mov_b32 s35, 0x20000
    s_lshl_b32 s23, s18, 1
    s_add_u32 s23, s23, s22
    s_lshl_b32 s19, s16, 5
    s_add_u32 s23, s23, s19
    s_lshl_b32 s52, s17, 3
    s_lshl_b32 s19, s21, 1
    s_add_u32 s52, s52, s19
    s_mov_b32 s54, 0x3e8293ee
    s_mov_b32 s55, 0x3e8293ee
    v_lshlrev_b32 v1, 4, v0
    v_and_b32 v8, 3, v0
    v_bfe_u32 v9, v0, 2, 2
    v_lshl_add_u32 v8, v9, 3, v8
    v_bfe_u32 v9, v0, 5, 1
    v_lshl_add_u32 v8, v9, 5, v8
    v_bfe_u32 v10, v0, 4, 1
    v_lshl_add_u32 v8, v10, 6, v8
    v_and_b32 v11, 15, v0
    v_lshl_add_u32 v11, v10, 5, v11
    v_lshl_add_u32 v11, v9, 6, v11
    s_lshr_b32 s19, s21, 1
    s_lshl_b32 s19, s19, 15
    s_lshl_b32 s53, s22, 14
    s_add_u32 s19, s19, s53
    s_and_b32 s49, s21, 1
    s_lshl_b32 s49, s49, 13
    s_add_u32 s19, s19, s49
    v_lshl_add_u32 v2, v8, 4, s19
    v_lshl_add_u32 v3, v11, 4, s19
    v_and_b32 v8, 15, v0
    v_mov_b32 v9, 0x3f803f80
    v_cmp_eq_u32 vcc, 0, v8
    v_cmp_eq_u32 s[38:39], 4, v8
    s_nop 1
    v_cndmask_b32 v166, 0, v9, vcc
    v_cndmask_b32 v167, 0, v9, s[38:39]
    s_cmp_lg_u32 s20, 2
    s_cbranch_scc1 L_notlb
    s_lshl_b32 s19, s23, 18
    s_lshl_b32 s38, s17, 15
    s_add_u32 s19, s19, s38
    s_add_u32 s19, s19, 8388608
    s_lshl_b32 s38, s16, 6
    s_add_u32 s38, s38, s52
    s_lshl_b32 s38, s38, 3
    s_lshr_b32 s39, s18, 1
    s_add_u32 s38, s38, s39
    s_lshl_b32 s38, s38, 2
    s_and_b32 s39, s18, 1
    s_add_u32 s38, s38, s39
    s_lshl_b32 s38, s38, 11
    s_add_u32 s38, s38, 25165824
    s_and_b32 s39, s14, 3
    s_lshl_b32 s39, s39, 2
    s_and_b32 s49, s15, 3
    s_add_u32 s39, s39, s49
    s_lshl_b32 s39, s39, 19
    s_lshl_b32 s49, s16, 11
    s_add_u32 s39, s39, s49
    s_lshr_b32 s49, s15, 2
    s_lshl_b32 s49, s49, 8
    s_add_u32 s39, s39, s49
    v_lshlrev_b32 v161, 18, v0
    v_lshlrev_b32 v164, 16, v0
    v_add_u32 v162, s39, v164
    s_sub_u32 s38, s38, 262144
    s_mov_b64 exec, 3
    buffer_load_dword v163, v161, s[32:35], s19 offen sc1
    s_mov_b64 exec, 0xff
    buffer_load_dword v163, v164, s[32:35], s38 offen sc1
    global_load_dword v163, v162, s[56:57] sc1
    s_mov_b32 exec_lo, -1
    buffer_load_dword v163, v164, s[76:79], 0 offen
    s_mov_b64 exec, -1
    s_cmp_eq_u32 s16, 0
    s_cselect_b32 s38, s6, s10
    s_cselect_b32 s39, s7, s11
    v_lshlrev_b32 v161, 20, v0
    s_mov_b64 exec, 0x3e
    global_load_dword v163, v161, s[38:39]
    s_mov_b64 exec, 1
    global_load_dword v163, v161, s[58:59] offset:128 sc1
    s_mov_b64 exec, -1
L_notlb:
    s_mov_b32 s40, 0
    s_mov_b32 s41, 0
    s_mov_b32 s42, 16
    s_mov_b32 s47, 12288
    s_mov_b32 s48, 32768
    s_waitcnt lgkmcnt(0)
    s_barrier
    ds_read_b128 v[16:19], v4 offset:0
    ds_read_b128 v[20:23], v4 offset:2048
    ds_read_b128 v[24:27], v4 offset:4096
    ds_read_b128 v[28:31], v4 offset:6144
    ds_read_b64_tr_b16 v[48:49], v6 offset:0
    ds_read_b64_tr_b16 v[50:51], v6 offset:512
    ds_read_b64_tr_b16 v[52:53], v7 offset:0
    ds_read_b64_tr_b16 v[54:55], v7 offset:512
    s_cmp_lg_u32 s20, 0
    s_cbranch_scc1 L_noat
    s_waitcnt vmcnt(0)
    s_mov_b64 exec, 1
    global_atomic_add v14, v15, s[58:59] sc1
    s_mov_b64 exec, -1
L_noat:
    s_cmp_eq_u32 s16, 0
    s_cselect_b32 s24, s4, s8
    s_cselect_b32 s25, s5, s9
    s_cselect_b32 s28, s6, s10
    s_cselect_b32 s29, s7, s11
    s_mov_b32 s26, 4194304
    s_mov_b32 s27, 0x20000
    s_mov_b32 s30, 6291456
    s_mov_b32 s31, 0x20000
    v_lshlrev_b32 v152, 7, v0
    s_lshl_b32 s36, s17, 4
    s_add_u32 s36, s36, s18
    s_lshl_b32 s37, s36, 15
    s_lshl_b32 s19, s20, 13
    s_add_u32 s37, s37, s19
    s_lshl_b32 s36, s36, 13
    s_cmp_ge_u32 s20, 4
    s_cbranch_scc1 L_pfw
    s_branch L_pfd
L_pfw:
    s_sub_u32 s19, s20, 4
    s_lshl_b32 s19, s19, 20
    s_add_u32 s19, s19, s36
    s_cmp_lg_u32 s20, 5
    s_cbranch_scc1 L_pfd
    buffer_load_dword v154, v152, s[28:31], s19 offen
L_pfd:
    s_lshl_b32 s49, s20, 20
    s_add_u32 s49, s49, s36
    s_lshl_b32 s50, s20, 1
    s_sub_u32 s50, 19, s50
    s_cmp_lt_u32 s20, 2
    s_cselect_b32 s50, 0, s50
.p2align 6
L_g_loop:
    s_waitcnt lgkmcnt(2)
    v_mfma_f32_16x16x32_bf16 v[56:59], v[48:51], v[16:19], v[56:59]
    ds_read_b128 v[32:35], v5 offset:0
    v_mfma_f32_16x16x32_bf16 v[80:83], v[48:51], v[20:23], v[80:83]
    ds_read_b64_tr_b16 v[8:9], v6 offset:4096
    v_mfma_f32_16x16x32_bf16 v[104:107], v[48:51], v[24:27], v[104:107]
    ds_read_b64_tr_b16 v[10:11], v6 offset:4608
    v_mfma_f32_16x16x32_bf16 v[128:131], v[48:51], v[28:31], v[128:131]
    s_add_u32 s40, s40, 1
    s_cmp_eq_u32 s40, 5
    s_waitcnt lgkmcnt(3)
    v_mfma_f32_16x16x32_bf16 v[60:63], v[52:55], v[16:19], v[60:63]
    ds_read_b128 v[36:39], v5 offset:2048
    v_mfma_f32_16x16x32_bf16 v[84:87], v[52:55], v[20:23], v[84:87]
    ds_read_b64_tr_b16 v[48:49], v7 offset:4096
    v_mfma_f32_16x16x32_bf16 v[108:111], v[52:55], v[24:27], v[108:111]
    ds_read_b64_tr_b16 v[50:51], v7 offset:4608
    v_mfma_f32_16x16x32_bf16 v[132:135], v[52:55], v[28:31], v[132:135]
    s_cselect_b32 s43, 4294918144, s47
    s_cselect_b32 s40, 0, s40
    s_waitcnt lgkmcnt(3)
    v_mfma_f32_16x16x32_bf16 v[64:67], v[8:11], v[16:19], v[64:67]
    ds_read_b128 v[40:43], v5 offset:4096
    v_mfma_f32_16x16x32_bf16 v[88:91], v[8:11], v[20:23], v[88:91]
    ds_read_b64_tr_b16 v[52:53], v6 offset:8192
    v_mfma_f32_16x16x32_bf16 v[112:115], v[8:11], v[24:27], v[112:115]
    ds_read_b64_tr_b16 v[54:55], v6 offset:8704
    v_mfma_f32_16x16x32_bf16 v[136:139], v[8:11], v[28:31], v[136:139]
    s_add_u32 s41, s41, 1
    s_cmp_eq_u32 s41, 3
    s_waitcnt lgkmcnt(3)
    v_mfma_f32_16x16x32_bf16 v[68:71], v[48:51], v[16:19], v[68:71]
    ds_read_b128 v[44:47], v5 offset:6144
    v_mfma_f32_16x16x32_bf16 v[92:95], v[48:51], v[20:23], v[92:95]
    ds_read_b64_tr_b16 v[8:9], v7 offset:8192
    v_mfma_f32_16x16x32_bf16 v[116:119], v[48:51], v[24:27], v[116:119]
    ds_read_b64_tr_b16 v[10:11], v7 offset:8704
    v_mfma_f32_16x16x32_bf16 v[140:143], v[48:51], v[28:31], v[140:143]
    v_add_u32 v6, s43, v6
    v_add_u32 v7, s43, v7
    s_waitcnt lgkmcnt(3)
    v_mfma_f32_16x16x32_bf16 v[72:75], v[16:19], v[52:55], v[72:75]
    ds_read_b64_tr_b16 v[48:49], v6 offset:0
    v_mfma_f32_16x16x32_bf16 v[96:99], v[20:23], v[52:55], v[96:99]
    ds_read_b64_tr_b16 v[50:51], v6 offset:512
    v_mfma_f32_16x16x32_bf16 v[120:123], v[24:27], v[52:55], v[120:123]
    s_cselect_b32 s44, 4294901760, s48
    s_cselect_b32 s41, 0, s41
    v_mfma_f32_16x16x32_bf16 v[144:147], v[28:31], v[52:55], v[144:147]
    v_add_u32 v4, s44, v4
    s_waitcnt lgkmcnt(2)
    v_mfma_f32_16x16x32_bf16 v[76:79], v[16:19], v[8:11], v[76:79]
    ds_read_b64_tr_b16 v[52:53], v7 offset:0
    v_mfma_f32_16x16x32_bf16 v[100:103], v[20:23], v[8:11], v[100:103]
    ds_read_b64_tr_b16 v[54:55], v7 offset:512
    v_mfma_f32_16x16x32_bf16 v[124:127], v[24:27], v[8:11], v[124:127]
    v_add_u32 v5, s44, v5
    v_mfma_f32_16x16x32_bf16 v[148:151], v[28:31], v[8:11], v[148:151]
    s_cmp_lg_u32 s42, s50
    s_cbranch_scc1 L_pfs
    buffer_load_dword v154, v152, s[28:31], s49 offen
L_pfs:
    s_barrier
    s_waitcnt lgkmcnt(2)
    v_mfma_f32_16x16x32_bf16 v[56:59], v[48:51], v[32:35], v[56:59]
    ds_read_b128 v[16:19], v4 offset:0
    v_mfma_f32_16x16x32_bf16 v[80:83], v[48:51], v[36:39], v[80:83]
    ds_read_b64_tr_b16 v[8:9], v6 offset:4096
    v_mfma_f32_16x16x32_bf16 v[104:107], v[48:51], v[40:43], v[104:107]
    ds_read_b64_tr_b16 v[10:11], v6 offset:4608
    v_mfma_f32_16x16x32_bf16 v[128:131], v[48:51], v[44:47], v[128:131]
    s_add_u32 s40, s40, 1
    s_cmp_eq_u32 s40, 5
    s_waitcnt lgkmcnt(3)
    v_mfma_f32_16x16x32_bf16 v[60:63], v[52:55], v[32:35], v[60:63]
    ds_read_b128 v[20:23], v4 offset:2048
    v_mfma_f32_16x16x32_bf16 v[84:87], v[52:55], v[36:39], v[84:87]
    ds_read_b64_tr_b16 v[48:49], v7 offset:4096
    v_mfma_f32_16x16x32_bf16 v[108:111], v[52:55], v[40:43], v[108:111]
    ds_read_b64_tr_b16 v[50:51], v7 offset:4608
    v_mfma_f32_16x16x32_bf16 v[132:135], v[52:55], v[44:47], v[132:135]
    s_cselect_b32 s43, 4294918144, s47
    s_cselect_b32 s40, 0, s40
    s_waitcnt lgkmcnt(3)
    v_mfma_f32_16x16x32_bf16 v[64:67], v[8:11], v[32:35], v[64:67]
    ds_read_b128 v[24:27], v4 offset:4096
    v_mfma_f32_16x16x32_bf16 v[88:91], v[8:11], v[36:39], v[88:91]
    ds_read_b64_tr_b16 v[52:53], v6 offset:8192
    v_mfma_f32_16x16x32_bf16 v[112:115], v[8:11], v[40:43], v[112:115]
    ds_read_b64_tr_b16 v[54:55], v6 offset:8704
    v_mfma_f32_16x16x32_bf16 v[136:139], v[8:11], v[44:47], v[136:139]
    s_waitcnt lgkmcnt(3)
    v_mfma_f32_16x16x32_bf16 v[68:71], v[48:51], v[32:35], v[68:71]
    ds_read_b128 v[28:31], v4 offset:6144
    v_mfma_f32_16x16x32_bf16 v[92:95], v[48:51], v[36:39], v[92:95]
    ds_read_b64_tr_b16 v[8:9], v7 offset:8192
    v_mfma_f32_16x16x32_bf16 v[116:119], v[48:51], v[40:43], v[116:119]
    ds_read_b64_tr_b16 v[10:11], v7 offset:8704
    v_mfma_f32_16x16x32_bf16 v[140:143], v[48:51], v[44:47], v[140:143]
    v_add_u32 v6, s43, v6
    v_add_u32 v7, s43, v7
    s_waitcnt lgkmcnt(3)
    v_mfma_f32_16x16x32_bf16 v[72:75], v[32:35], v[52:55], v[72:75]
    ds_read_b64_tr_b16 v[48:49], v6 offset:0
    v_mfma_f32_16x16x32_bf16 v[96:99], v[36:39], v[52:55], v[96:99]
    ds_read_b64_tr_b16 v[50:51], v6 offset:512
    v_mfma_f32_16x16x32_bf16 v[120:123], v[40:43], v[52:55], v[120:123]
    s_sub_u32 s42, s42, 1
    s_cmp_lg_u32 s42, 0
    v_mfma_f32_16x16x32_bf16 v[144:147], v[44:47], v[52:55], v[144:147]
    s_waitcnt lgkmcnt(2)
    v_mfma_f32_16x16x32_bf16 v[76:79], v[32:35], v[8:11], v[76:79]
    ds_read_b64_tr_b16 v[52:53], v7 offset:0
    v_mfma_f32_16x16x32_bf16 v[100:103], v[36:39], v[8:11], v[100:103]
    ds_read_b64_tr_b16 v[54:55], v7 offset:512
    v_mfma_f32_16x16x32_bf16 v[124:127], v[40:43], v[8:11], v[124:127]
    v_mfma_f32_16x16x32_bf16 v[148:151], v[44:47], v[8:11], v[148:151]
    s_barrier
    s_cbranch_scc1 L_g_loop
    s_setprio 0
    v_cvt_pk_bf16_f32 v64, v64, v65
    v_cvt_pk_bf16_f32 v65, v66, v67
    v_cvt_pk_bf16_f32 v66, v68, v69
    v_cvt_pk_bf16_f32 v67, v70, v71
    ds_write_b128 v2, v[64:67] offset:0
    v_cvt_pk_bf16_f32 v88, v88, v89
    v_cvt_pk_bf16_f32 v89, v90, v91
    v_cvt_pk_bf16_f32 v90, v92, v93
    v_cvt_pk_bf16_f32 v91, v94, v95
    ds_write_b128 v2, v[88:91] offset:64
    v_cvt_pk_bf16_f32 v112, v112, v113
    v_cvt_pk_bf16_f32 v113, v114, v115
    v_cvt_pk_bf16_f32 v114, v116, v117
    v_cvt_pk_bf16_f32 v115, v118, v119
    ds_write_b128 v2, v[112:115] offset:4096
    v_cvt_pk_bf16_f32 v136, v136, v137
    v_cvt_pk_bf16_f32 v137, v138, v139
    v_cvt_pk_bf16_f32 v138, v140, v141
    v_cvt_pk_bf16_f32 v139, v142, v143
    ds_write_b128 v2, v[136:139] offset:4160
    v_cvt_pk_bf16_f32 v72, v72, v73
    v_cvt_pk_bf16_f32 v73, v74, v75
    v_cvt_pk_bf16_f32 v74, v96, v97
    v_cvt_pk_bf16_f32 v75, v98, v99
    ds_write_b128 v3, v[72:75] offset:2048
    v_cvt_pk_bf16_f32 v76, v76, v77
    v_cvt_pk_bf16_f32 v77, v78, v79
    v_cvt_pk_bf16_f32 v78, v100, v101
    v_cvt_pk_bf16_f32 v79, v102, v103
    ds_write_b128 v3, v[76:79] offset:2304
    v_cvt_pk_bf16_f32 v120, v120, v121
    v_cvt_pk_bf16_f32 v121, v122, v123
    v_cvt_pk_bf16_f32 v122, v144, v145
    v_cvt_pk_bf16_f32 v123, v146, v147
    ds_write_b128 v3, v[120:123] offset:6144
    v_cvt_pk_bf16_f32 v124, v124, v125
    v_cvt_pk_bf16_f32 v125, v126, v127
    v_cvt_pk_bf16_f32 v126, v148, v149
    v_cvt_pk_bf16_f32 v127, v150, v151
    ds_write_b128 v3, v[124:127] offset:6400
    v_pk_mul_f32 v[56:57], v[56:57], s[54:55]
    v_pk_mul_f32 v[58:59], v[58:59], s[54:55]
    v_pk_mul_f32 v[60:61], v[60:61], s[54:55]
    v_pk_mul_f32 v[62:63], v[62:63], s[54:55]
    v_cvt_pk_bf16_f32 v32, v56, v57
    v_cvt_pk_bf16_f32 v33, v58, v59
    v_cvt_pk_bf16_f32 v34, v60, v61
    v_cvt_pk_bf16_f32 v35, v62, v63
    v_pk_mul_f32 v[80:81], v[80:81], s[54:55]
    v_pk_mul_f32 v[82:83], v[82:83], s[54:55]
    v_pk_mul_f32 v[84:85], v[84:85], s[54:55]
    v_pk_mul_f32 v[86:87], v[86:87], s[54:55]
    v_cvt_pk_bf16_f32 v36, v80, v81
    v_cvt_pk_bf16_f32 v37, v82, v83
    v_cvt_pk_bf16_f32 v38, v84, v85
    v_cvt_pk_bf16_f32 v39, v86, v87
    v_pk_mul_f32 v[104:105], v[104:105], s[54:55]
    v_pk_mul_f32 v[106:107], v[106:107], s[54:55]
    v_pk_mul_f32 v[108:109], v[108:109], s[54:55]
    v_pk_mul_f32 v[110:111], v[110:111], s[54:55]
    v_cvt_pk_bf16_f32 v40, v104, v105
    v_cvt_pk_bf16_f32 v41, v106, v107
    v_cvt_pk_bf16_f32 v42, v108, v109
    v_cvt_pk_bf16_f32 v43, v110, v111
    v_pk_mul_f32 v[128:129], v[128:129], s[54:55]
    v_pk_mul_f32 v[130:131], v[130:131], s[54:55]
    v_pk_mul_f32 v[132:133], v[132:133], s[54:55]
    v_pk_mul_f32 v[134:135], v[134:135], s[54:55]
    v_cvt_pk_bf16_f32 v44, v128, v129
    v_cvt_pk_bf16_f32 v45, v130, v131
    v_cvt_pk_bf16_f32 v46, v132, v133
    v_cvt_pk_bf16_f32 v47, v134, v135
    v_add_u32 v5, s53, v1
    v_add_u32 v6, 32768, v5
    v_permlane16_swap_b32 v64, v88
    v_permlane16_swap_b32 v65, v89
    v_permlane16_swap_b32 v66, v90
    v_permlane16_swap_b32 v67, v91
    v_permlane16_swap_b32 v32, v36
    v_permlane16_swap_b32 v33, v37
    v_permlane16_swap_b32 v34, v38
    v_permlane16_swap_b32 v35, v39
    v_permlane16_swap_b32 v40, v44
    v_permlane16_swap_b32 v41, v45
    v_permlane16_swap_b32 v42, v46
    v_permlane16_swap_b32 v43, v47
    s_waitcnt vmcnt(0)
    v_mov_b32 v7, 0xdddd
    v_mfma_f32_32x32x16_bf16 v[104:119], v[64:67], v[32:35], 0
    v_mfma_f32_32x32x16_bf16 v[104:119], v[88:91], v[36:39], v[104:119]
    v_mfma_f32_32x32x16_bf16 v[120:135], v[64:67], v[40:43], 0
    v_mfma_f32_32x32x16_bf16 v[120:135], v[88:91], v[44:47], v[120:135]
    s_waitcnt lgkmcnt(0)
    s_barrier
    ds_read_b128 v[16:19], v5
    ds_read_b128 v[20:23], v5 offset:1024
    v_mov_b32 v8, v166
    v_mov_b32 v9, v166
    v_mov_b32 v10, v167
    v_mov_b32 v11, v167
    v_mov_b32 v4, v165
    v_mov_b32 v48, 0
    v_mov_b32 v52, 0
    v_mov_b32 v49, 0
    v_mov_b32 v53, 0
    v_mov_b32 v50, 0
    v_mov_b32 v54, 0
    v_mov_b32 v51, 0
    v_mov_b32 v55, 0
    v_max3_f32 v136, v104, v105, v106
    v_max3_f32 v137, v107, v108, v109
    v_max3_f32 v138, v110, v111, v112
    v_max3_f32 v139, v113, v114, v115
    v_max3_f32 v136, v136, v116, v117
    v_max3_f32 v137, v137, v118, v119
    v_max3_f32 v136, v136, v138, v139
    v_max_f32 v14, v136, v137
    v_max3_f32 v136, v120, v121, v122
    v_max3_f32 v137, v123, v124, v125
    v_max3_f32 v138, v126, v127, v128
    v_max3_f32 v139, v129, v130, v131
    v_max3_f32 v136, v136, v132, v133
    v_max3_f32 v137, v137, v134, v135
    v_max3_f32 v136, v136, v138, v139
    v_max3_f32 v14, v14, v136, v137
    v_mov_b32 v136, v14
    s_nop 1
    v_permlane32_swap_b32 v14, v136
    s_nop 1
    v_max_f32 v14, v14, v136
    v_sub_f32 v88, 0, v14
    v_sub_f32 v89, 0, v14
    v_sub_f32 v90, 0, v14
    v_sub_f32 v91, 0, v14
    v_sub_f32 v92, 0, v14
    v_sub_f32 v93, 0, v14
    v_sub_f32 v94, 0, v14
    v_sub_f32 v95, 0, v14
    v_sub_f32 v96, 0, v14
    v_sub_f32 v97, 0, v14
    v_sub_f32 v98, 0, v14
    v_sub_f32 v99, 0, v14
    v_sub_f32 v100, 0, v14
    v_sub_f32 v101, 0, v14
    v_sub_f32 v102, 0, v14
    v_sub_f32 v103, 0, v14
    s_waitcnt lgkmcnt(0)
    s_nop 0
    v_mfma_f32_32x32x16_bf16 v[104:119], v[16:19], v[32:35], v[88:103]
    v_mfma_f32_32x32x16_bf16 v[104:119], v[20:23], v[36:39], v[104:119]
    v_mfma_f32_32x32x16_bf16 v[136:151], v[16:19], v[40:43], v[88:103]
    v_mfma_f32_32x32x16_bf16 v[136:151], v[20:23], v[44:47], v[136:151]
    ds_read_b128 v[16:19], v5 offset:4096
    ds_read_b128 v[20:23], v5 offset:5120
    ds_read_b128 v[24:27], v5 offset:2048
    ds_read_b128 v[28:31], v5 offset:3072
    v_mov_b32 v56, 0
    v_mov_b32 v72, 0
    v_mov_b32 v57, 0
    v_mov_b32 v73, 0
    v_mov_b32 v58, 0
    v_mov_b32 v74, 0
    v_mov_b32 v59, 0
    v_mov_b32 v75, 0
    v_mov_b32 v60, 0
    v_mov_b32 v76, 0
    v_mov_b32 v61, 0
    v_mov_b32 v77, 0
    v_mov_b32 v62, 0
    v_mov_b32 v78, 0
    v_mov_b32 v63, 0
    v_mov_b32 v79, 0
    v_mov_b32 v64, 0
    v_mov_b32 v80, 0
    v_mov_b32 v65, 0
    v_mov_b32 v81, 0
    v_mov_b32 v66, 0
    v_mov_b32 v82, 0
    v_mov_b32 v67, 0
    v_mov_b32 v83, 0
    v_mov_b32 v68, 0
    v_mov_b32 v84, 0
    v_mov_b32 v69, 0
    v_mov_b32 v85, 0
    v_mov_b32 v70, 0
    v_mov_b32 v86, 0
    v_mov_b32 v71, 0
    v_mov_b32 v87, 0
    v_mov_b32 v12, 0
    v_mov_b32 v13, 0
    v_mov_b32 v14, 0
    v_mov_b32 v15, 0
    v_mov_b32 v128, 0
    v_mov_b32 v160, 0
    v_mov_b32 v129, 0
    v_mov_b32 v161, 0
    v_mov_b32 v130, 0
    v_mov_b32 v162, 0
    v_mov_b32 v131, 0
    v_mov_b32 v163, 0
    v_mov_b32 v132, 0
    v_mov_b32 v164, 0
    v_mov_b32 v133, 0
    v_mov_b32 v165, 0
    v_mov_b32 v134, 0
    v_mov_b32 v166, 0
    v_mov_b32 v135, 0
    v_mov_b32 v167, 0
    s_mov_b32 s42, 16
    s_cmp_lt_u32 s20, 4
    s_mov_b32 s50, 65528
    s_mov_b32 s51, 131070
    s_cselect_b32 s50, 63480, s50
    s_cselect_b32 s51, 129016, s51
.p2align 6
L_a_loop:
    v_smfmac_f32_32x32x32_bf16 v[56:71], v[12:15], v[128:135], v7
    v_exp_f32 v104, v104
    v_exp_f32 v105, v105
    v_exp_f32 v106, v106
    v_smfmac_f32_16x16x64_bf16 v[48:51], v[8:11], v[128:135], v7
    v_exp_f32 v107, v107
    v_exp_f32 v108, v108
    v_smfmac_f32_32x32x32_bf16 v[72:87], v[12:15], v[160:167], v7
    v_exp_f32 v109, v109
    v_exp_f32 v110, v110
    v_exp_f32 v111, v111
    v_smfmac_f32_16x16x64_bf16 v[52:55], v[8:11], v[160:167], v7
    v_exp_f32 v136, v136
    v_exp_f32 v137, v137
    s_waitcnt lgkmcnt(0)
    v_mfma_f32_32x32x16_bf16 v[120:135], v[16:19], v[32:35], v[88:103]
    s_bitcmp1_b32 s51, s42
    s_cbranch_scc0 L_a_nop0
    s_setprio 0
L_a_nop0:
    ds_read_b128 v[12:15], v5 offset:7168
    v_exp_f32 v138, v138
    v_exp_f32 v139, v139
    v_exp_f32 v140, v140
    v_mfma_f32_32x32x16_bf16 v[152:167], v[16:19], v[40:43], v[88:103]
    ds_read_b128 v[16:19], v5 offset:8192
    v_exp_f32 v141, v141
    v_exp_f32 v142, v142
    v_exp_f32 v143, v143
    v_mfma_f32_32x32x16_bf16 v[120:135], v[20:23], v[36:39], v[120:135]
    v_exp_f32 v112, v112
    v_exp_f32 v113, v113
    v_exp_f32 v114, v114
    v_mfma_f32_32x32x16_bf16 v[152:167], v[20:23], v[44:47], v[152:167]
    ds_read_b128 v[20:23], v5 offset:9216
    v_exp_f32 v115, v115
    v_exp_f32 v116, v116
    v_exp_f32 v117, v117
    v_smfmac_f32_32x32x32_bf16 v[56:71], v[24:27], v[104:111], v7
    v_exp_f32 v118, v118
    v_exp_f32 v119, v119
    v_exp_f32 v144, v144
    v_smfmac_f32_16x16x64_bf16 v[48:51], v[8:11], v[104:111], v7
    v_exp_f32 v145, v145
    v_exp_f32 v146, v146
    v_smfmac_f32_32x32x32_bf16 v[72:87], v[24:27], v[136:143], v7
    ds_read_b128 v[24:27], v5 offset:6144
    v_exp_f32 v147, v147
    v_exp_f32 v148, v148
    v_exp_f32 v149, v149
    v_smfmac_f32_16x16x64_bf16 v[52:55], v[8:11], v[136:143], v7
    v_exp_f32 v150, v150
    v_exp_f32 v151, v151
    v_smfmac_f32_32x32x32_bf16 v[56:71], v[28:31], v[112:119], v7
    v_exp_f32 v120, v120
    v_exp_f32 v121, v121
    v_exp_f32 v122, v122
    v_smfmac_f32_16x16x64_bf16 v[48:51], v[8:11], v[112:119], v7
    v_exp_f32 v123, v123
    v_exp_f32 v124, v124
    v_smfmac_f32_32x32x32_bf16 v[72:87], v[28:31], v[144:151], v7
    v_exp_f32 v125, v125
    v_exp_f32 v126, v126
    v_exp_f32 v127, v127
    v_smfmac_f32_16x16x64_bf16 v[52:55], v[8:11], v[144:151], v7
    v_exp_f32 v152, v152
    v_exp_f32 v153, v153
    s_waitcnt lgkmcnt(0)
    v_mfma_f32_32x32x16_bf16 v[104:119], v[16:19], v[32:35], v[88:103]
    ds_read_b128 v[28:31], v5 offset:11264
    v_exp_f32 v154, v154
    v_exp_f32 v155, v155
    v_exp_f32 v156, v156
    v_mfma_f32_32x32x16_bf16 v[136:151], v[16:19], v[40:43], v[88:103]
    ds_read_b128 v[16:19], v5 offset:12288
    v_exp_f32 v157, v157
    v_exp_f32 v158, v158
    v_exp_f32 v159, v159
    v_mfma_f32_32x32x16_bf16 v[104:119], v[20:23], v[36:39], v[104:119]
    v_exp_f32 v128, v128
    v_exp_f32 v129, v129
    v_exp_f32 v130, v130
    v_mfma_f32_32x32x16_bf16 v[136:151], v[20:23], v[44:47], v[136:151]
    ds_read_b128 v[20:23], v5 offset:13312
    v_exp_f32 v131, v131
    v_exp_f32 v132, v132
    v_exp_f32 v133, v133
    v_smfmac_f32_32x32x32_bf16 v[56:71], v[24:27], v[120:127], v7
    v_exp_f32 v134, v134
    v_exp_f32 v135, v135
    v_exp_f32 v160, v160
    v_smfmac_f32_16x16x64_bf16 v[48:51], v[8:11], v[120:127], v7
    v_exp_f32 v161, v161
    v_exp_f32 v162, v162
    v_smfmac_f32_32x32x32_bf16 v[72:87], v[24:27], v[152:159], v7
    ds_read_b128 v[24:27], v5 offset:10240
    v_exp_f32 v163, v163
    v_exp_f32 v164, v164
    v_exp_f32 v165, v165
    v_smfmac_f32_16x16x64_bf16 v[52:55], v[8:11], v[152:159], v7
    v_exp_f32 v166, v166
    v_exp_f32 v167, v167
    v_smfmac_f32_32x32x32_bf16 v[56:71], v[12:15], v[128:135], v7
    v_exp_f32 v104, v104
    v_exp_f32 v105, v105
    v_exp_f32 v106, v106
    v_smfmac_f32_16x16x64_bf16 v[48:51], v[8:11], v[128:135], v7
    v_exp_f32 v107, v107
    v_exp_f32 v108, v108
    v_smfmac_f32_32x32x32_bf16 v[72:87], v[12:15], v[160:167], v7
    v_exp_f32 v109, v109
    v_exp_f32 v110, v110
    v_exp_f32 v111, v111
    v_smfmac_f32_16x16x64_bf16 v[52:55], v[8:11], v[160:167], v7
    v_exp_f32 v136, v136
    v_exp_f32 v137, v137
    s_waitcnt lgkmcnt(0)
    v_mfma_f32_32x32x16_bf16 v[120:135], v[16:19], v[32:35], v[88:103]
    s_bitcmp1_b32 s50, s42
    s_cbranch_scc0 L_a_nob0
    s_barrier
L_a_nob0:
    s_setprio 1
    ds_read_b128 v[12:15], v5 offset:15360
    v_exp_f32 v138, v138
    v_exp_f32 v139, v139
    v_exp_f32 v140, v140
    v_mfma_f32_32x32x16_bf16 v[152:167], v[16:19], v[40:43], v[88:103]
    ds_read_b128 v[16:19], v6 offset:0
    v_exp_f32 v141, v141
    v_exp_f32 v142, v142
    v_exp_f32 v143, v143
    v_mfma_f32_32x32x16_bf16 v[120:135], v[20:23], v[36:39], v[120:135]
    v_exp_f32 v112, v112
    v_exp_f32 v113, v113
    v_exp_f32 v114, v114
    v_mfma_f32_32x32x16_bf16 v[152:167], v[20:23], v[44:47], v[152:167]
    ds_read_b128 v[20:23], v6 offset:1024
    v_exp_f32 v115, v115
    v_exp_f32 v116, v116
    v_exp_f32 v117, v117
    v_smfmac_f32_32x32x32_bf16 v[56:71], v[24:27], v[104:111], v7
    v_exp_f32 v118, v118
    v_exp_f32 v119, v119
    v_exp_f32 v144, v144
    v_smfmac_f32_16x16x64_bf16 v[48:51], v[8:11], v[104:111], v7
    v_exp_f32 v145, v145
    v_exp_f32 v146, v146
    v_smfmac_f32_32x32x32_bf16 v[72:87], v[24:27], v[136:143], v7
    ds_read_b128 v[24:27], v5 offset:14336
    v_exp_f32 v147, v147
    v_exp_f32 v148, v148
    v_exp_f32 v149, v149
    v_smfmac_f32_16x16x64_bf16 v[52:55], v[8:11], v[136:143], v7
    v_exp_f32 v150, v150
    v_exp_f32 v151, v151
    v_smfmac_f32_32x32x32_bf16 v[56:71], v[28:31], v[112:119], v7
    v_exp_f32 v120, v120
    v_exp_f32 v121, v121
    v_exp_f32 v122, v122
    v_smfmac_f32_16x16x64_bf16 v[48:51], v[8:11], v[112:119], v7
    v_exp_f32 v123, v123
    v_exp_f32 v124, v124
    v_smfmac_f32_32x32x32_bf16 v[72:87], v[28:31], v[144:151], v7
    v_exp_f32 v125, v125
    v_exp_f32 v126, v126
    v_exp_f32 v127, v127
    v_smfmac_f32_16x16x64_bf16 v[52:55], v[8:11], v[144:151], v7
    v_exp_f32 v152, v152
    v_exp_f32 v153, v153
    s_waitcnt lgkmcnt(0)
    v_mfma_f32_32x32x16_bf16 v[104:119], v[16:19], v[32:35], v[88:103]
    ds_read_b128 v[28:31], v6 offset:3072
    v_exp_f32 v154, v154
    v_exp_f32 v155, v155
    v_exp_f32 v156, v156
    v_mfma_f32_32x32x16_bf16 v[136:151], v[16:19], v[40:43], v[88:103]
    ds_read_b128 v[16:19], v6 offset:4096
    v_exp_f32 v157, v157
    v_exp_f32 v158, v158
    v_exp_f32 v159, v159
    v_mfma_f32_32x32x16_bf16 v[104:119], v[20:23], v[36:39], v[104:119]
    v_exp_f32 v128, v128
    v_exp_f32 v129, v129
    v_exp_f32 v130, v130
    v_mfma_f32_32x32x16_bf16 v[136:151], v[20:23], v[44:47], v[136:151]
    ds_read_b128 v[20:23], v6 offset:5120
    v_exp_f32 v131, v131
    v_exp_f32 v132, v132
    v_exp_f32 v133, v133
    v_smfmac_f32_32x32x32_bf16 v[56:71], v[24:27], v[120:127], v7
    v_exp_f32 v134, v134
    v_exp_f32 v135, v135
    v_exp_f32 v160, v160
    v_smfmac_f32_16x16x64_bf16 v[48:51], v[8:11], v[120:127], v7
    v_exp_f32 v161, v161
    v_exp_f32 v162, v162
    v_smfmac_f32_32x32x32_bf16 v[72:87], v[24:27], v[152:159], v7
    ds_read_b128 v[24:27], v6 offset:2048
    v_exp_f32 v163, v163
    v_exp_f32 v164, v164
    v_exp_f32 v165, v165
    v_smfmac_f32_16x16x64_bf16 v[52:55], v[8:11], v[152:159], v7
    v_exp_f32 v166, v166
    v_exp_f32 v167, v167
    v_mov_b32 v5, v6
    v_add_u32 v6, 32768, v6
    v_and_b32 v6, 0x1ffff, v6
    s_sub_u32 s42, s42, 1
    s_cmp_lg_u32 s42, 0
    s_cbranch_scc1 L_a_loop
    v_smfmac_f32_32x32x32_bf16 v[56:71], v[12:15], v[128:135], v7
    v_smfmac_f32_16x16x64_bf16 v[48:51], v[8:11], v[128:135], v7
    v_smfmac_f32_32x32x32_bf16 v[72:87], v[12:15], v[160:167], v7
    v_smfmac_f32_16x16x64_bf16 v[52:55], v[8:11], v[160:167], v7
    s_mov_b32 s45, 0
    s_lshl_b32 s19, s16, 6
    s_add_u32 s19, s19, s52
    s_lshl_b32 s19, s19, 3
    s_lshr_b32 s37, s18, 1
    s_add_u32 s19, s19, s37
    s_lshl_b32 s19, s19, 1
    s_add_u32 s19, s19, s22
    s_lshl_b32 s19, s19, 1
    s_and_b32 s37, s18, 1
    s_add_u32 s19, s19, s37
    s_lshl_b32 s19, s19, 11
    s_add_u32 s38, s19, 25165824
    s_add_u32 s39, s38, 65536
    s_waitcnt lgkmcnt(0)
L_a_store:
    v_mov_b32 v49, v48
    v_mov_b32 v53, v52
    s_nop 1
    v_permlane32_swap_b32 v48, v49
    v_permlane32_swap_b32 v52, v53
    s_nop 1
    v_rcp_f32 v104, v48
    s_nop 0
    v_mul_f32 v56, v56, v104
    v_mul_f32 v57, v57, v104
    v_mul_f32 v58, v58, v104
    v_mul_f32 v59, v59, v104
    v_mul_f32 v60, v60, v104
    v_mul_f32 v61, v61, v104
    v_mul_f32 v62, v62, v104
    v_mul_f32 v63, v63, v104
    v_mul_f32 v64, v64, v104
    v_mul_f32 v65, v65, v104
    v_mul_f32 v66, v66, v104
    v_mul_f32 v67, v67, v104
    v_mul_f32 v68, v68, v104
    v_mul_f32 v69, v69, v104
    v_mul_f32 v70, v70, v104
    v_mul_f32 v71, v71, v104
    v_rcp_f32 v105, v52
    v_cvt_pk_bf16_f32 v136, v56, v57
    v_cvt_pk_bf16_f32 v137, v58, v59
    v_cvt_pk_bf16_f32 v138, v60, v61
    v_cvt_pk_bf16_f32 v139, v62, v63
    v_cvt_pk_bf16_f32 v140, v64, v65
    v_cvt_pk_bf16_f32 v141, v66, v67
    v_cvt_pk_bf16_f32 v142, v68, v69
    v_cvt_pk_bf16_f32 v143, v70, v71
    buffer_store_dwordx4 v[136:139], v1, s[32:35], s38 offen sc1
    buffer_store_dwordx4 v[140:143], v1, s[32:35], s38 offen offset:1024 sc1
    v_mul_f32 v72, v72, v105
    v_mul_f32 v73, v73, v105
    v_mul_f32 v74, v74, v105
    v_mul_f32 v75, v75, v105
    v_mul_f32 v76, v76, v105
    v_mul_f32 v77, v77, v105
    v_mul_f32 v78, v78, v105
    v_mul_f32 v79, v79, v105
    v_mul_f32 v80, v80, v105
    v_mul_f32 v81, v81, v105
    v_mul_f32 v82, v82, v105
    v_mul_f32 v83, v83, v105
    v_mul_f32 v84, v84, v105
    v_mul_f32 v85, v85, v105
    v_mul_f32 v86, v86, v105
    v_mul_f32 v87, v87, v105
    v_cvt_pk_bf16_f32 v144, v72, v73
    v_cvt_pk_bf16_f32 v145, v74, v75
    v_cvt_pk_bf16_f32 v146, v76, v77
    v_cvt_pk_bf16_f32 v147, v78, v79
    v_cvt_pk_bf16_f32 v148, v80, v81
    v_cvt_pk_bf16_f32 v149, v82, v83
    v_cvt_pk_bf16_f32 v150, v84, v85
    v_cvt_pk_bf16_f32 v151, v86, v87
    buffer_store_dwordx4 v[144:147], v1, s[32:35], s39 offen sc1
    buffer_store_dwordx4 v[148:151], v1, s[32:35], s39 offen offset:1024 sc1
    s_cmp_lt_u32 s20, 4
    s_cbranch_scc1 L_a_chk
    s_cmp_lg_u32 s45, 0
    s_cbranch_scc1 L_a_chk
    s_barrier
    s_setprio 3
    v_mov_b32 v152, v4
    v_add_u32 v153, 16384, v4
    v_add_u32 v154, 128, v4
    v_add_u32 v155, 128, v153
    s_add_u32 m0, s90, 0
    s_nop 0
    buffer_load_dwordx4 v152, s[76:79], s94 offen lds
    s_add_u32 m0, s90, 1024
    s_nop 0
    buffer_load_dwordx4 v153, s[76:79], s94 offen lds
    s_add_u32 m0, s90, 8192
    s_nop 0
    buffer_load_dwordx4 v154, s[76:79], s94 offen lds
    s_add_u32 m0, s90, 9216
    s_nop 0
    buffer_load_dwordx4 v155, s[76:79], s94 offen lds
    s_add_u32 s94, s94, 262144
    s_and_b32 s94, s94, 2097151
    s_cmp_eq_u32 s94, s95
    s_cselect_b32 s19, 65536, 0
    s_or_b32 s94, s94, s19
    s_add_u32 s90, s90, 32768
    s_sub_u32 s19, s90, 163840
    s_cmp_ge_u32 s90, 163840
    s_cselect_b32 s90, s19, s90
    s_barrier
L_a_chk:
    v_add_f32 v105, v56, v72
    v_add_f32 v106, v57, v73
    v_add_f32 v105, v105, v58
    v_add_f32 v106, v106, v74
    v_add_f32 v105, v105, v59
    v_add_f32 v106, v106, v75
    v_add_f32 v105, v105, v60
    v_add_f32 v106, v106, v76
    v_add_f32 v105, v105, v61
    v_add_f32 v106, v106, v77
    v_add_f32 v105, v105, v62
    v_add_f32 v106, v106, v78
    v_add_f32 v105, v105, v63
    v_add_f32 v106, v106, v79
    v_add_f32 v105, v105, v64
    v_add_f32 v106, v106, v80
    v_add_f32 v105, v105, v65
    v_add_f32 v106, v106, v81
    v_add_f32 v105, v105, v66
    v_add_f32 v106, v106, v82
    v_add_f32 v105, v105, v67
    v_add_f32 v106, v106, v83
    v_add_f32 v105, v105, v68
    v_add_f32 v106, v106, v84
    v_add_f32 v105, v105, v69
    v_add_f32 v106, v106, v85
    v_add_f32 v105, v105, v70
    v_add_f32 v106, v106, v86
    v_add_f32 v105, v105, v71
    v_add_f32 v106, v106, v87
    v_add_f32 v105, v105, v106
    v_mov_b32 v107, 0x71800000
    v_mov_b32 v111, 0x21800000
    v_mov_b32 v108, 0x7f7fffff
    v_cmp_nle_f32 vcc, v48, v107
    v_cmp_nle_f32 s[46:47], v52, v107
    v_cmp_nge_f32 s[48:49], v48, v111
    v_cmp_nge_f32 s[50:51], v52, v111
    s_or_b64 s[46:47], s[46:47], vcc
    v_cmp_nle_f32 vcc, |v105|, v108
    s_or_b64 s[48:49], s[48:49], s[50:51]
    s_or_b64 s[46:47], s[46:47], s[48:49]
    s_nop 1
    s_or_b64 s[46:47], s[46:47], vcc
    s_cmp_eq_u64 s[46:47], 0
    s_cbranch_scc1 L_a_ok
    s_cmp_eq_u32 s45, 0
    s_cbranch_scc1 L_slow
L_a_ok:
    s_lshl_b32 s19, s16, 4
    s_add_u32 s19, s19, s18
    s_lshl_b32 s19, s19, 3
    s_add_u32 s19, s19, s17
    s_lshl_b32 s19, s19, 5
    s_add_u32 s19, s19, s20
    s_lshl_b32 s19, s19, 2
    s_add_u32 s19, s19, 33554464
    v_mov_b32 v12, s19
    v_mov_b32 v13, 1
    s_cmp_lt_u32 s20, 4
    s_cbranch_scc1 L_o_setup
    s_branch L_helper
    s_barrier
    s_branch L_o_pub
L_o_setup:
    s_lshr_b32 s21, s20, 1
    s_and_b32 s22, s20, 1
    v_lshlrev_b32 v4, 4, v0
    s_lshl_b32 s19, s21, 13
    s_add_u32 s19, s19, 131072
    v_add_u32 v4, s19, v4
    v_lshrrev_b32 v2, 5, v0
    v_bfe_u32 v9, v0, 2, 2
    v_lshl_add_u32 v10, v2, 2, v9
    v_lshlrev_b32 v10, 7, v10
    v_and_b32 v11, 1, v0
    v_lshl_add_u32 v10, v11, 6, v10
    v_bfe_u32 v11, v0, 4, 1
    v_lshl_add_u32 v10, v11, 4, v10
    v_bfe_u32 v11, v0, 1, 1
    v_lshl_add_u32 v10, v11, 3, v10
    v_bfe_u32 v11, v0, 3, 1
    v_lshl_add_u32 v10, v11, 5, v10
    s_lshl_b32 s19, s22, 13
    s_add_u32 s19, s19, 147456
    v_add_u32 v5, s19, v10
    v_xor_b32 v6, 32, v5
    s_mov_b32 s41, 4
    s_mov_b32 s48, 32768
    s_barrier
L_o_pub:
    s_waitcnt vmcnt(0)
    s_mov_b64 exec, 1
    buffer_store_dword v13, v12, s[32:35], 0 offen sc1
    s_mov_b64 exec, -1
    s_setprio 0
    s_cmp_ge_u32 s20, 4
    s_cbranch_scc1 L_hend
    v_mov_b32 v48, 0
    v_mov_b32 v49, 0
    v_mov_b32 v50, 0
    v_mov_b32 v51, 0
    v_mov_b32 v52, 0
    v_mov_b32 v53, 0
    v_mov_b32 v54, 0
    v_mov_b32 v55, 0
    v_mov_b32 v56, 0
    v_mov_b32 v57, 0
    v_mov_b32 v58, 0
    v_mov_b32 v59, 0
    v_mov_b32 v60, 0
    v_mov_b32 v61, 0
    v_mov_b32 v62, 0
    v_mov_b32 v63, 0
    v_mov_b32 v64, 0
    v_mov_b32 v65, 0
    v_mov_b32 v66, 0
    v_mov_b32 v67, 0
    v_mov_b32 v68, 0
    v_mov_b32 v69, 0
    v_mov_b32 v70, 0
    v_mov_b32 v71, 0
    v_mov_b32 v72, 0
    v_mov_b32 v73, 0
    v_mov_b32 v74, 0
    v_mov_b32 v75, 0
    v_mov_b32 v76, 0
    v_mov_b32 v77, 0
    v_mov_b32 v78, 0
    v_mov_b32 v79, 0
    v_mov_b32 v80, 0
    v_mov_b32 v81, 0
    v_mov_b32 v82, 0
    v_mov_b32 v83, 0
    v_mov_b32 v84, 0
    v_mov_b32 v85, 0
    v_mov_b32 v86, 0
    v_mov_b32 v87, 0
    v_mov_b32 v88, 0
    v_mov_b32 v89, 0
    v_mov_b32 v90, 0
    v_mov_b32 v91, 0
    v_mov_b32 v92, 0
    v_mov_b32 v93, 0
    v_mov_b32 v94, 0
    v_mov_b32 v95, 0
    v_mov_b32 v96, 0
    v_mov_b32 v97, 0
    v_mov_b32 v98, 0
    v_mov_b32 v99, 0
    v_mov_b32 v100, 0
    v_mov_b32 v101, 0
    v_mov_b32 v102, 0
    v_mov_b32 v103, 0
    v_mov_b32 v104, 0
    v_mov_b32 v105, 0
    v_mov_b32 v106, 0
    v_mov_b32 v107, 0
    v_mov_b32 v108, 0
    v_mov_b32 v109, 0
    v_mov_b32 v110, 0
    v_mov_b32 v111, 0
    s_mov_b32 s28, s56
    s_mov_b32 s29, s57
    s_mov_b32 s30, 8388608
    s_mov_b32 s31, 0x20000
    s_and_b32 s36, s14, 3
    s_lshl_b32 s36, s36, 2
    s_and_b32 s19, s15, 3
    s_add_u32 s36, s36, s19
    s_lshl_b32 s36, s36, 7
    s_lshl_b32 s19, s21, 6
    s_add_u32 s36, s36, s19
    s_lshl_b32 s36, s36, 12
    s_lshl_b32 s19, s16, 11
    s_add_u32 s36, s36, s19
    s_lshr_b32 s19, s15, 2
    s_lshl_b32 s19, s19, 8
    s_add_u32 s36, s36, s19
    s_lshl_b32 s19, s22, 7
    s_add_u32 s36, s36, s19
    s_lshl_b32 s19, s20, 13
    s_add_u32 s19, s19, 65536
    v_and_b32 v7, 31, v0
    v_lshrrev_b32 v8, 5, v0
    v_lshlrev_b32 v8, 2, v8
    v_and_b32 v9, 7, v0
    v_xor_b32 v8, v8, v9
    v_lshlrev_b32 v8, 4, v8
    v_lshl_add_u32 v8, v7, 7, v8
    v_add_u32 v144, s19, v8
    v_xor_b32 v145, 16, v144
    v_xor_b32 v146, 32, v144
    v_xor_b32 v147, 48, v144
    v_lshrrev_b32 v7, 3, v0
    v_xor_b32 v8, v7, v9
    v_lshlrev_b32 v8, 4, v8
    v_lshl_add_u32 v8, v7, 7, v8
    v_add_u32 v148, s19, v8
    v_lshlrev_b32 v149, 4, v9
    v_lshl_add_u32 v149, v7, 12, v149
    s_mov_b32 s42, 16
    s_barrier
    ds_read_b128 v[16:19], v4 offset:0
    ds_read_b64_tr_b16 v[24:25], v5 offset:0
    ds_read_b64_tr_b16 v[26:27], v5 offset:1024
    ds_read_b64_tr_b16 v[28:29], v6 offset:0
    ds_read_b64_tr_b16 v[30:31], v6 offset:1024
    ds_read_b128 v[20:23], v4 offset:4096
.p2align 6
L_o_loop:
    s_waitcnt lgkmcnt(0)
    v_mfma_f32_32x32x16_bf16 v[48:63], v[24:27], v[16:19], v[48:63]
    ds_read_b128 v[32:35], v4 offset:1024
    ds_read_b64_tr_b16 v[40:41], v5 offset:2048
    ds_read_b64_tr_b16 v[42:43], v5 offset:3072
    v_mfma_f32_32x32x16_bf16 v[64:79], v[28:31], v[16:19], v[64:79]
    ds_read_b64_tr_b16 v[44:45], v6 offset:2048
    ds_read_b64_tr_b16 v[46:47], v6 offset:3072
    ds_read_b128 v[36:39], v4 offset:5120
    v_mfma_f32_32x32x16_bf16 v[80:95], v[24:27], v[20:23], v[80:95]
    s_add_u32 s41, s41, 1
    s_cmp_eq_u32 s41, 5
    s_cselect_b32 s44, 4294836224, s48
    s_cselect_b32 s41, 0, s41
    v_mfma_f32_32x32x16_bf16 v[96:111], v[28:31], v[20:23], v[96:111]
    s_waitcnt lgkmcnt(0)
    v_mfma_f32_32x32x16_bf16 v[48:63], v[40:43], v[32:35], v[48:63]
    ds_read_b128 v[16:19], v4 offset:2048
    ds_read_b64_tr_b16 v[24:25], v5 offset:4096
    ds_read_b64_tr_b16 v[26:27], v5 offset:5120
    v_mfma_f32_32x32x16_bf16 v[64:79], v[44:47], v[32:35], v[64:79]
    ds_read_b64_tr_b16 v[28:29], v6 offset:4096
    ds_read_b64_tr_b16 v[30:31], v6 offset:5120
    ds_read_b128 v[20:23], v4 offset:6144
    v_mfma_f32_32x32x16_bf16 v[80:95], v[40:43], v[36:39], v[80:95]
    s_barrier
    v_mfma_f32_32x32x16_bf16 v[96:111], v[44:47], v[36:39], v[96:111]
    s_waitcnt lgkmcnt(0)
    v_mfma_f32_32x32x16_bf16 v[48:63], v[24:27], v[16:19], v[48:63]
    ds_read_b128 v[32:35], v4 offset:3072
    ds_read_b64_tr_b16 v[40:41], v5 offset:6144
    ds_read_b64_tr_b16 v[42:43], v5 offset:7168
    v_mfma_f32_32x32x16_bf16 v[64:79], v[28:31], v[16:19], v[64:79]
    ds_read_b64_tr_b16 v[44:45], v6 offset:6144
    ds_read_b64_tr_b16 v[46:47], v6 offset:7168
    ds_read_b128 v[36:39], v4 offset:7168
    v_mfma_f32_32x32x16_bf16 v[80:95], v[24:27], v[20:23], v[80:95]
    v_add_u32 v4, s44, v4
    v_add_u32 v5, s44, v5
    v_add_u32 v6, s44, v6
    v_mfma_f32_32x32x16_bf16 v[96:111], v[28:31], v[20:23], v[96:111]
    s_waitcnt lgkmcnt(0)
    v_mfma_f32_32x32x16_bf16 v[48:63], v[40:43], v[32:35], v[48:63]
    ds_read_b128 v[16:19], v4 offset:0
    ds_read_b64_tr_b16 v[24:25], v5 offset:0
    ds_read_b64_tr_b16 v[26:27], v5 offset:1024
    v_mfma_f32_32x32x16_bf16 v[64:79], v[44:47], v[32:35], v[64:79]
    ds_read_b64_tr_b16 v[28:29], v6 offset:0
    ds_read_b64_tr_b16 v[30:31], v6 offset:1024
    ds_read_b128 v[20:23], v4 offset:4096
    v_mfma_f32_32x32x16_bf16 v[80:95], v[40:43], v[36:39], v[80:95]
    s_sub_u32 s42, s42, 1
    s_cmp_lg_u32 s42, 0
    v_mfma_f32_32x32x16_bf16 v[96:111], v[44:47], v[36:39], v[96:111]
    s_cbranch_scc1 L_o_loop
    s_nop 1
    v_cvt_pk_bf16_f32 v48, v48, v49
    v_cvt_pk_bf16_f32 v49, v50, v51
    v_cvt_pk_bf16_f32 v50, v52, v53
    v_cvt_pk_bf16_f32 v51, v54, v55
    v_cvt_pk_bf16_f32 v52, v56, v57
    v_cvt_pk_bf16_f32 v53, v58, v59
    v_cvt_pk_bf16_f32 v54, v60, v61
    v_cvt_pk_bf16_f32 v55, v62, v63
    ds_write_b128 v144, v[48:51] offset:0
    ds_write_b128 v145, v[52:55] offset:0
    v_cvt_pk_bf16_f32 v64, v64, v65
    v_cvt_pk_bf16_f32 v65, v66, v67
    v_cvt_pk_bf16_f32 v66, v68, v69
    v_cvt_pk_bf16_f32 v67, v70, v71
    v_cvt_pk_bf16_f32 v68, v72, v73
    v_cvt_pk_bf16_f32 v69, v74, v75
    v_cvt_pk_bf16_f32 v70, v76, v77
    v_cvt_pk_bf16_f32 v71, v78, v79
    ds_write_b128 v146, v[64:67] offset:0
    ds_write_b128 v147, v[68:71] offset:0
    ds_read_b128 v[112:115], v148 offset:0
    ds_read_b128 v[116:119], v148 offset:1024
    ds_read_b128 v[120:123], v148 offset:2048
    ds_read_b128 v[124:127], v148 offset:3072
    v_cvt_pk_bf16_f32 v80, v80, v81
    v_cvt_pk_bf16_f32 v81, v82, v83
    v_cvt_pk_bf16_f32 v82, v84, v85
    v_cvt_pk_bf16_f32 v83, v86, v87
    v_cvt_pk_bf16_f32 v84, v88, v89
    v_cvt_pk_bf16_f32 v85, v90, v91
    v_cvt_pk_bf16_f32 v86, v92, v93
    v_cvt_pk_bf16_f32 v87, v94, v95
    ds_write_b128 v144, v[80:83] offset:4096
    ds_write_b128 v145, v[84:87] offset:4096
    s_waitcnt lgkmcnt(4)
    buffer_store_dwordx4 v[112:115], v149, s[28:31], s36 offen sc1
    s_add_u32 s36, s36, 32768
    buffer_store_dwordx4 v[116:119], v149, s[28:31], s36 offen sc1
    s_add_u32 s36, s36, 32768
    v_cvt_pk_bf16_f32 v96, v96, v97
    v_cvt_pk_bf16_f32 v97, v98, v99
    v_cvt_pk_bf16_f32 v98, v100, v101
    v_cvt_pk_bf16_f32 v99, v102, v103
    v_cvt_pk_bf16_f32 v100, v104, v105
    v_cvt_pk_bf16_f32 v101, v106, v107
    v_cvt_pk_bf16_f32 v102, v108, v109
    v_cvt_pk_bf16_f32 v103, v110, v111
    ds_write_b128 v146, v[96:99] offset:4096
    ds_write_b128 v147, v[100:103] offset:4096
    s_waitcnt lgkmcnt(4)
    buffer_store_dwordx4 v[120:123], v149, s[28:31], s36 offen sc1
    s_add_u32 s36, s36, 32768
    buffer_store_dwordx4 v[124:127], v149, s[28:31], s36 offen sc1
    s_add_u32 s36, s36, 32768
    ds_read_b128 v[128:131], v148 offset:4096
    ds_read_b128 v[132:135], v148 offset:5120
    ds_read_b128 v[136:139], v148 offset:6144
    ds_read_b128 v[140:143], v148 offset:7168
    s_waitcnt lgkmcnt(3)
    buffer_store_dwordx4 v[128:131], v149, s[28:31], s36 offen sc1
    s_add_u32 s36, s36, 32768
    s_waitcnt lgkmcnt(2)
    buffer_store_dwordx4 v[132:135], v149, s[28:31], s36 offen sc1
    s_add_u32 s36, s36, 32768
    s_waitcnt lgkmcnt(1)
    buffer_store_dwordx4 v[136:139], v149, s[28:31], s36 offen sc1
    s_add_u32 s36, s36, 32768
    s_waitcnt lgkmcnt(0)
    buffer_store_dwordx4 v[140:143], v149, s[28:31], s36 offen sc1
    s_add_u32 s36, s36, 32768
L_cend:
    s_endpgm
L_hend:
    s_barrier
    s_barrier
    s_endpgm
L_helper:
    s_cmp_eq_u32 s45, 0
    s_cbranch_scc1 L_hp1
    s_waitcnt vmcnt(0)
L_hp1:
    s_waitcnt vmcnt(4)
    s_mov_b64 exec, 1
    buffer_store_dword v13, v12, s[32:35], 0 offen sc1
    s_mov_b64 exec, -1
    s_add_u32 m0, s90, 0
    s_nop 0
    buffer_load_dwordx4 v152, s[76:79], s94 offen lds
    s_add_u32 m0, s90, 1024
    s_nop 0
    buffer_load_dwordx4 v153, s[76:79], s94 offen lds
    s_add_u32 m0, s90, 8192
    s_nop 0
    buffer_load_dwordx4 v154, s[76:79], s94 offen lds
    s_add_u32 m0, s90, 9216
    s_nop 0
    buffer_load_dwordx4 v155, s[76:79], s94 offen lds
    s_add_u32 s94, s94, 262144
    s_and_b32 s94, s94, 2097151
    s_cmp_eq_u32 s94, s95
    s_cselect_b32 s19, 65536, 0
    s_or_b32 s94, s94, s19
    s_add_u32 s90, s90, 32768
    s_sub_u32 s19, s90, 163840
    s_cmp_ge_u32 s90, 163840
    s_cselect_b32 s90, s19, s90
    s_add_u32 m0, s90, 0
    s_nop 0
    buffer_load_dwordx4 v152, s[76:79], s94 offen lds
    s_add_u32 m0, s90, 1024
    s_nop 0
    buffer_load_dwordx4 v153, s[76:79], s94 offen lds
    s_add_u32 m0, s90, 8192
    s_nop 0
    buffer_load_dwordx4 v154, s[76:79], s94 offen lds
    s_add_u32 m0, s90, 9216
    s_nop 0
    buffer_load_dwordx4 v155, s[76:79], s94 offen lds
    s_add_u32 s94, s94, 262144
    s_and_b32 s94, s94, 2097151
    s_cmp_eq_u32 s94, s95
    s_cselect_b32 s19, 65536, 0
    s_or_b32 s94, s94, s19
    s_add_u32 s90, s90, 32768
    s_sub_u32 s19, s90, 163840
    s_cmp_ge_u32 s90, 163840
    s_cselect_b32 s90, s19, s90
    s_waitcnt vmcnt(9)
    s_barrier
    s_add_u32 m0, s90, 0
    s_nop 0
    buffer_load_dwordx4 v152, s[76:79], s94 offen lds
    s_add_u32 m0, s90, 1024
    s_nop 0
    buffer_load_dwordx4 v153, s[76:79], s94 offen lds
    s_add_u32 m0, s90, 8192
    s_nop 0
    buffer_load_dwordx4 v154, s[76:79], s94 offen lds
    s_add_u32 m0, s90, 9216
    s_nop 0
    buffer_load_dwordx4 v155, s[76:79], s94 offen lds
    s_add_u32 s94, s94, 262144
    s_and_b32 s94, s94, 2097151
    s_cmp_eq_u32 s94, s95
    s_cselect_b32 s19, 65536, 0
    s_or_b32 s94, s94, s19
    s_add_u32 s90, s90, 32768
    s_sub_u32 s19, s90, 163840
    s_cmp_ge_u32 s90, 163840
    s_cselect_b32 s90, s19, s90
    s_waitcnt vmcnt(8)
    s_barrier
    s_add_u32 m0, s90, 0
    s_nop 0
    buffer_load_dwordx4 v152, s[76:79], s94 offen lds
    s_add_u32 m0, s90, 1024
    s_nop 0
    buffer_load_dwordx4 v153, s[76:79], s94 offen lds
    s_add_u32 m0, s90, 8192
    s_nop 0
    buffer_load_dwordx4 v154, s[76:79], s94 offen lds
    s_add_u32 m0, s90, 9216
    s_nop 0
    buffer_load_dwordx4 v155, s[76:79], s94 offen lds
    s_add_u32 s94, s94, 262144
    s_and_b32 s94, s94, 2097151
    s_cmp_eq_u32 s94, s95
    s_cselect_b32 s19, 65536, 0
    s_or_b32 s94, s94, s19
    s_add_u32 s90, s90, 32768
    s_sub_u32 s19, s90, 163840
    s_cmp_ge_u32 s90, 163840
    s_cselect_b32 s90, s19, s90
    s_waitcnt vmcnt(8)
    s_mov_b32 s42, 9
L_hl_loop:
    s_barrier
    s_add_u32 m0, s90, 0
    s_nop 0
    buffer_load_dwordx4 v152, s[76:79], s94 offen lds
    s_add_u32 m0, s90, 1024
    s_nop 0
    buffer_load_dwordx4 v153, s[76:79], s94 offen lds
    s_add_u32 m0, s90, 8192
    s_nop 0
    buffer_load_dwordx4 v154, s[76:79], s94 offen lds
    s_add_u32 m0, s90, 9216
    s_nop 0
    buffer_load_dwordx4 v155, s[76:79], s94 offen lds
    s_add_u32 s94, s94, 262144
    s_and_b32 s94, s94, 2097151
    s_cmp_eq_u32 s94, s95
    s_cselect_b32 s19, 65536, 0
    s_or_b32 s94, s94, s19
    s_add_u32 s90, s90, 32768
    s_sub_u32 s19, s90, 163840
    s_cmp_ge_u32 s90, 163840
    s_cselect_b32 s90, s19, s90
    s_sub_u32 s42, s42, 1
    s_waitcnt vmcnt(8)
    s_cmp_lg_u32 s42, 0
    s_cbranch_scc1 L_hl_loop
    s_barrier
    s_waitcnt vmcnt(4)
    s_barrier
    s_waitcnt vmcnt(0)
    s_barrier
    s_endpgm
L_slow:
    s_mov_b32 s45, 1
    s_waitcnt vmcnt(0)
    s_lshl_b32 s19, s23, 18
    s_add_u32 s43, s19, 8388608
    s_add_u32 s44, s43, 262144
    v_mov_b32 v14, 0xff800000
    s_mov_b32 s42, s43
L_slow_max0:
    buffer_load_dwordx4 v[16:19], v1, s[32:35], s42 offen sc1
    buffer_load_dwordx4 v[20:23], v1, s[32:35], s42 offen offset:1024 sc1
    s_waitcnt vmcnt(0)
    v_mfma_f32_32x32x16_bf16 v[104:119], v[16:19], v[32:35], 0
    v_mfma_f32_32x32x16_bf16 v[104:119], v[20:23], v[36:39], v[104:119]
    s_nop 15
    v_max3_f32 v136, v104, v105, v106
    v_max3_f32 v137, v107, v108, v109
    v_max3_f32 v138, v110, v111, v112
    v_max3_f32 v139, v113, v114, v115
    v_max3_f32 v136, v136, v116, v117
    v_max3_f32 v137, v137, v118, v119
    v_max3_f32 v136, v136, v138, v139
    v_max3_f32 v14, v14, v136, v137
    s_add_u32 s42, s42, 4096
    s_cmp_lt_u32 s42, s44
    s_cbranch_scc1 L_slow_max0
    v_mov_b32 v136, v14
    s_nop 1
    v_permlane32_swap_b32 v14, v136
    s_nop 1
    v_max_f32 v14, v14, v136
    v_sub_f32 v88, 0, v14
    v_sub_f32 v89, 0, v14
    v_sub_f32 v90, 0, v14
    v_sub_f32 v91, 0, v14
    v_sub_f32 v92, 0, v14
    v_sub_f32 v93, 0, v14
    v_sub_f32 v94, 0, v14
    v_sub_f32 v95, 0, v14
    v_sub_f32 v96, 0, v14
    v_sub_f32 v97, 0, v14
    v_sub_f32 v98, 0, v14
    v_sub_f32 v99, 0, v14
    v_sub_f32 v100, 0, v14
    v_sub_f32 v101, 0, v14
    v_sub_f32 v102, 0, v14
    v_sub_f32 v103, 0, v14
    v_mov_b32 v56, 0
    v_mov_b32 v57, 0
    v_mov_b32 v58, 0
    v_mov_b32 v59, 0
    v_mov_b32 v60, 0
    v_mov_b32 v61, 0
    v_mov_b32 v62, 0
    v_mov_b32 v63, 0
    v_mov_b32 v64, 0
    v_mov_b32 v65, 0
    v_mov_b32 v66, 0
    v_mov_b32 v67, 0
    v_mov_b32 v68, 0
    v_mov_b32 v69, 0
    v_mov_b32 v70, 0
    v_mov_b32 v71, 0
    v_mov_b32 v48, 0
    v_mov_b32 v49, 0
    v_mov_b32 v50, 0
    v_mov_b32 v51, 0
    s_mov_b32 s42, s43
L_slow_main0:
    buffer_load_dwordx4 v[16:19], v1, s[32:35], s42 offen sc1
    buffer_load_dwordx4 v[20:23], v1, s[32:35], s42 offen offset:1024 sc1
    buffer_load_dwordx4 v[24:27], v1, s[32:35], s42 offen offset:2048 sc1
    buffer_load_dwordx4 v[28:31], v1, s[32:35], s42 offen offset:3072 sc1
    s_waitcnt vmcnt(0)
    v_mfma_f32_32x32x16_bf16 v[104:119], v[16:19], v[32:35], v[88:103]
    v_mfma_f32_32x32x16_bf16 v[104:119], v[20:23], v[36:39], v[104:119]
    s_nop 15
    v_exp_f32 v104, v104
    v_exp_f32 v105, v105
    v_exp_f32 v106, v106
    v_exp_f32 v107, v107
    v_exp_f32 v108, v108
    v_exp_f32 v109, v109
    v_exp_f32 v110, v110
    v_exp_f32 v111, v111
    v_exp_f32 v112, v112
    v_exp_f32 v113, v113
    v_exp_f32 v114, v114
    v_exp_f32 v115, v115
    v_exp_f32 v116, v116
    v_exp_f32 v117, v117
    v_exp_f32 v118, v118
    v_exp_f32 v119, v119
    s_nop 1
    v_smfmac_f32_32x32x32_bf16 v[56:71], v[24:27], v[104:111], v7
    v_smfmac_f32_32x32x32_bf16 v[56:71], v[28:31], v[112:119], v7
    v_smfmac_f32_16x16x64_bf16 v[48:51], v[8:11], v[104:111], v7
    v_smfmac_f32_16x16x64_bf16 v[48:51], v[8:11], v[112:119], v7
    s_nop 7
    s_add_u32 s42, s42, 4096
    s_cmp_lt_u32 s42, s44
    s_cbranch_scc1 L_slow_main0
    v_mov_b32 v14, 0xff800000
    s_mov_b32 s42, s43
L_slow_max1:
    buffer_load_dwordx4 v[16:19], v1, s[32:35], s42 offen sc1
    buffer_load_dwordx4 v[20:23], v1, s[32:35], s42 offen offset:1024 sc1
    s_waitcnt vmcnt(0)
    v_mfma_f32_32x32x16_bf16 v[104:119], v[16:19], v[40:43], 0
    v_mfma_f32_32x32x16_bf16 v[104:119], v[20:23], v[44:47], v[104:119]
    s_nop 15
    v_max3_f32 v136, v104, v105, v106
    v_max3_f32 v137, v107, v108, v109
    v_max3_f32 v138, v110, v111, v112
    v_max3_f32 v139, v113, v114, v115
    v_max3_f32 v136, v136, v116, v117
    v_max3_f32 v137, v137, v118, v119
    v_max3_f32 v136, v136, v138, v139
    v_max3_f32 v14, v14, v136, v137
    s_add_u32 s42, s42, 4096
    s_cmp_lt_u32 s42, s44
    s_cbranch_scc1 L_slow_max1
    v_mov_b32 v136, v14
    s_nop 1
    v_permlane32_swap_b32 v14, v136
    s_nop 1
    v_max_f32 v14, v14, v136
    v_sub_f32 v88, 0, v14
    v_sub_f32 v89, 0, v14
    v_sub_f32 v90, 0, v14
    v_sub_f32 v91, 0, v14
    v_sub_f32 v92, 0, v14
    v_sub_f32 v93, 0, v14
    v_sub_f32 v94, 0, v14
    v_sub_f32 v95, 0, v14
    v_sub_f32 v96, 0, v14
    v_sub_f32 v97, 0, v14
    v_sub_f32 v98, 0, v14
    v_sub_f32 v99, 0, v14
    v_sub_f32 v100, 0, v14
    v_sub_f32 v101, 0, v14
    v_sub_f32 v102, 0, v14
    v_sub_f32 v103, 0, v14
    v_mov_b32 v72, 0
    v_mov_b32 v73, 0
    v_mov_b32 v74, 0
    v_mov_b32 v75, 0
    v_mov_b32 v76, 0
    v_mov_b32 v77, 0
    v_mov_b32 v78, 0
    v_mov_b32 v79, 0
    v_mov_b32 v80, 0
    v_mov_b32 v81, 0
    v_mov_b32 v82, 0
    v_mov_b32 v83, 0
    v_mov_b32 v84, 0
    v_mov_b32 v85, 0
    v_mov_b32 v86, 0
    v_mov_b32 v87, 0
    v_mov_b32 v52, 0
    v_mov_b32 v53, 0
    v_mov_b32 v54, 0
    v_mov_b32 v55, 0
    s_mov_b32 s42, s43
L_slow_main1:
    buffer_load_dwordx4 v[16:19], v1, s[32:35], s42 offen sc1
    buffer_load_dwordx4 v[20:23], v1, s[32:35], s42 offen offset:1024 sc1
    buffer_load_dwordx4 v[24:27], v1, s[32:35], s42 offen offset:2048 sc1
    buffer_load_dwordx4 v[28:31], v1, s[32:35], s42 offen offset:3072 sc1
    s_waitcnt vmcnt(0)
    v_mfma_f32_32x32x16_bf16 v[104:119], v[16:19], v[40:43], v[88:103]
    v_mfma_f32_32x32x16_bf16 v[104:119], v[20:23], v[44:47], v[104:119]
    s_nop 15
    v_exp_f32 v104, v104
    v_exp_f32 v105, v105
    v_exp_f32 v106, v106
    v_exp_f32 v107, v107
    v_exp_f32 v108, v108
    v_exp_f32 v109, v109
    v_exp_f32 v110, v110
    v_exp_f32 v111, v111
    v_exp_f32 v112, v112
    v_exp_f32 v113, v113
    v_exp_f32 v114, v114
    v_exp_f32 v115, v115
    v_exp_f32 v116, v116
    v_exp_f32 v117, v117
    v_exp_f32 v118, v118
    v_exp_f32 v119, v119
    s_nop 1
    v_smfmac_f32_32x32x32_bf16 v[72:87], v[24:27], v[104:111], v7
    v_smfmac_f32_32x32x32_bf16 v[72:87], v[28:31], v[112:119], v7
    v_smfmac_f32_16x16x64_bf16 v[52:55], v[8:11], v[104:111], v7
    v_smfmac_f32_16x16x64_bf16 v[52:55], v[8:11], v[112:119], v7
    s_nop 7
    s_add_u32 s42, s42, 4096
    s_cmp_lt_u32 s42, s44
    s_cbranch_scc1 L_slow_main1
    s_nop 15
    s_branch L_a_store
L_loader2:
    s_lshl_b32 s36, s16, 4
    s_add_u32 s36, s36, s18
    s_lshl_b32 s36, s36, 3
    s_add_u32 s37, s36, s17
    s_lshl_b32 s37, s37, 7
    s_add_u32 s37, s37, 33554432
    s_lshl_b32 s19, s21, 2
    s_add_u32 s19, s19, s37
    v_mov_b32 v20, s19
    s_add_u32 s19, s37, 16
    v_mov_b32 v21, s19
    v_mov_b32 v22, 1
    v_mov_b32 v23, 2
    v_mov_b32 v24, 0
    s_lshl_b32 s19, s36, 7
    s_add_u32 s19, s19, 33554432
    s_lshl_b32 s39, s21, 2
    s_add_u32 s39, s39, s19
    v_and_b32 v25, 7, v0
    v_lshlrev_b32 v25, 7, v25
    v_add_u32 v25, s39, v25
    s_add_u32 s19, s17, 1
    v_and_b32 v28, 1, v0
    v_add_u32 v28, s19, v28
    v_and_b32 v28, 7, v28
    v_lshlrev_b32 v28, 7, v28
    v_add_u32 v28, s39, v28
    s_and_b32 s38, s14, 3
    s_lshl_b32 s38, s38, 2
    s_and_b32 s19, s15, 3
    s_add_u32 s38, s38, s19
    s_lshr_b32 s19, s38, 1
    s_lshl_b32 s39, s16, 7
    s_add_u32 s19, s19, s39
    s_lshl_b32 s19, s19, 7
    s_add_u32 s19, s19, 33554464
    s_and_b32 s39, s38, 1
    s_lshl_b32 s39, s39, 3
    s_add_u32 s19, s19, s39
    s_lshr_b32 s39, s21, 1
    s_lshl_b32 s39, s39, 2
    s_add_u32 s19, s19, s39
    s_add_u32 s49, s14, 1
    s_and_b32 s49, s49, 3
    s_lshl_b32 s49, s49, 2
    v_add_u32 v26, s49, v0
    v_and_b32 v26, 15, v26
    v_lshlrev_b32 v26, 10, v26
    v_and_b32 v27, 16, v0
    v_add_u32 v26, v27, v26
    v_add_u32 v26, s19, v26
    s_lshl_b32 s19, s16, 5
    s_lshl_b32 s39, s18, 1
    s_add_u32 s19, s19, s39
    s_lshl_b32 s19, s19, 18
    s_add_u32 s19, s19, 8388608
    s_add_u32 s24, s12, s19
    s_addc_u32 s25, s13, 0
    s_mov_b32 s26, 524288
    s_mov_b32 s27, 0x20000
    v_lshlrev_b32 v8, 4, v0
    s_and_b32 s19, s21, 1
    s_lshl_b32 s19, s19, 13
    s_lshr_b32 s39, s21, 1
    s_lshl_b32 s39, s39, 18
    s_add_u32 s19, s19, s39
    v_add_u32 v9, s19, v8
    v_add_u32 v10, 4096, v9
    s_lshl_b32 s19, s21, 13
    v_add_u32 v11, s19, v8
    s_lshl_b32 s47, s17, 15
    s_add_u32 s48, s47, 16384
    s_add_u32 s40, s47, 32768
    s_and_b32 s40, s40, 0x3ffff
    s_add_u32 s50, s40, 16384
    s_add_u32 s43, s19, 65536
    s_waitcnt vmcnt(0)
    s_barrier
    s_barrier
    s_barrier
    ds_read_b128 v[32:35], v11 offset:0
    ds_read_b128 v[36:39], v11 offset:1024
    ds_read_b128 v[40:43], v11 offset:2048
    ds_read_b128 v[44:47], v11 offset:3072
    ds_read_b128 v[48:51], v11 offset:4096
    ds_read_b128 v[52:55], v11 offset:5120
    ds_read_b128 v[56:59], v11 offset:6144
    ds_read_b128 v[60:63], v11 offset:7168
    s_waitcnt lgkmcnt(7)
    buffer_store_dwordx4 v[32:35], v9, s[24:27], s47 offen offset:0 sc1
    s_waitcnt lgkmcnt(6)
    buffer_store_dwordx4 v[36:39], v9, s[24:27], s47 offen offset:1024 sc1
    s_waitcnt lgkmcnt(5)
    buffer_store_dwordx4 v[40:43], v9, s[24:27], s47 offen offset:2048 sc1
    s_waitcnt lgkmcnt(4)
    buffer_store_dwordx4 v[44:47], v9, s[24:27], s47 offen offset:3072 sc1
    s_waitcnt lgkmcnt(3)
    buffer_store_dwordx4 v[48:51], v10, s[24:27], s47 offen offset:0 sc1
    s_waitcnt lgkmcnt(2)
    buffer_store_dwordx4 v[52:55], v10, s[24:27], s47 offen offset:1024 sc1
    s_waitcnt lgkmcnt(1)
    buffer_store_dwordx4 v[56:59], v10, s[24:27], s47 offen offset:2048 sc1
    s_waitcnt lgkmcnt(0)
    buffer_store_dwordx4 v[60:63], v10, s[24:27], s47 offen offset:3072 sc1
    ds_read_b128 v[64:67], v11 offset:32768
    ds_read_b128 v[68:71], v11 offset:33792
    ds_read_b128 v[72:75], v11 offset:34816
    ds_read_b128 v[76:79], v11 offset:35840
    ds_read_b128 v[80:83], v11 offset:36864
    ds_read_b128 v[84:87], v11 offset:37888
    ds_read_b128 v[88:91], v11 offset:38912
    ds_read_b128 v[92:95], v11 offset:39936
    s_mov_b32 s46, 131072
    s_mov_b32 exec_lo, 1
    s_mov_b32 exec_hi, 0
L_poll0:
    global_load_dword v27, v24, s[58:59] sc1
    s_waitcnt vmcnt(0)
    v_cmp_gt_u32 vcc, 256, v27
    s_sub_u32 s46, s46, 1
    s_cbranch_scc1 L_poll0_y
    s_cmp_eq_u64 vcc, 0
    s_cbranch_scc1 L_poll0_y
    s_sleep 4
    s_branch L_poll0
L_poll0_y:
    s_mov_b64 exec, -1
L_poll0_x:
    s_mov_b64 exec, 1
    buffer_store_dword v22, v20, s[32:35], 0 offen sc1
    s_mov_b64 exec, -1
    s_mov_b32 s46, 131072
    s_mov_b32 exec_lo, 3
    s_mov_b32 exec_hi, 0
L_poll1:
    buffer_load_dword v27, v28, s[32:35], 0 offen sc1
    s_waitcnt vmcnt(0)
    v_cmp_gt_u32 vcc, 1, v27
    s_sub_u32 s46, s46, 1
    s_cbranch_scc1 L_poll1_y
    s_cmp_eq_u64 vcc, 0
    s_cbranch_scc1 L_poll1_y
    s_sleep 1
    s_branch L_poll1
L_poll1_y:
    s_mov_b64 exec, -1
L_poll1_x:
    s_add_u32 m0, s43, 0
    s_nop 0
    buffer_load_dwordx4 v9, s[24:27], s40 offen offset:0 sc1 lds
    buffer_load_dwordx4 v9, s[24:27], s40 offen offset:1024 sc1 lds
    buffer_load_dwordx4 v9, s[24:27], s40 offen offset:2048 sc1 lds
    buffer_load_dwordx4 v9, s[24:27], s40 offen offset:3072 sc1 lds
    s_add_u32 m0, s43, 4096
    s_nop 0
    buffer_load_dwordx4 v10, s[24:27], s40 offen offset:0 sc1 lds
    buffer_load_dwordx4 v10, s[24:27], s40 offen offset:1024 sc1 lds
    buffer_load_dwordx4 v10, s[24:27], s40 offen offset:2048 sc1 lds
    buffer_load_dwordx4 v10, s[24:27], s40 offen offset:3072 sc1 lds
    s_add_u32 s40, s40, 32768
    s_and_b32 s40, s40, 0x3ffff
    s_cmp_eq_u32 s40, s47
    s_cselect_b32 s40, s50, s40
    s_add_u32 s43, s43, 32768
    s_and_b32 s43, s43, 0x1ffff
    s_add_u32 m0, s43, 0
    s_nop 0
    buffer_load_dwordx4 v9, s[24:27], s40 offen offset:0 sc1 lds
    buffer_load_dwordx4 v9, s[24:27], s40 offen offset:1024 sc1 lds
    buffer_load_dwordx4 v9, s[24:27], s40 offen offset:2048 sc1 lds
    buffer_load_dwordx4 v9, s[24:27], s40 offen offset:3072 sc1 lds
    s_add_u32 m0, s43, 4096
    s_nop 0
    buffer_load_dwordx4 v10, s[24:27], s40 offen offset:0 sc1 lds
    buffer_load_dwordx4 v10, s[24:27], s40 offen offset:1024 sc1 lds
    buffer_load_dwordx4 v10, s[24:27], s40 offen offset:2048 sc1 lds
    buffer_load_dwordx4 v10, s[24:27], s40 offen offset:3072 sc1 lds
    s_add_u32 s40, s40, 32768
    s_and_b32 s40, s40, 0x3ffff
    s_cmp_eq_u32 s40, s47
    s_cselect_b32 s40, s50, s40
    s_add_u32 s43, s43, 32768
    s_and_b32 s43, s43, 0x1ffff
    s_waitcnt vmcnt(8) lgkmcnt(0)
    s_barrier
    s_mov_b32 s46, 131072
    s_mov_b32 exec_lo, 0xff
    s_mov_b32 exec_hi, 0
L_poll1b:
    buffer_load_dword v27, v25, s[32:35], 0 offen sc1
    s_waitcnt vmcnt(0)
    v_cmp_gt_u32 vcc, 1, v27
    s_sub_u32 s46, s46, 1
    s_cbranch_scc1 L_poll1b_y
    s_cmp_eq_u64 vcc, 0
    s_cbranch_scc1 L_poll1b_y
    s_sleep 4
    s_branch L_poll1b
L_poll1b_y:
    s_mov_b64 exec, -1
L_poll1b_x:
    s_add_u32 m0, s43, 0
    s_nop 0
    buffer_load_dwordx4 v9, s[24:27], s40 offen offset:0 sc1 lds
    buffer_load_dwordx4 v9, s[24:27], s40 offen offset:1024 sc1 lds
    buffer_load_dwordx4 v9, s[24:27], s40 offen offset:2048 sc1 lds
    buffer_load_dwordx4 v9, s[24:27], s40 offen offset:3072 sc1 lds
    s_add_u32 m0, s43, 4096
    s_nop 0
    buffer_load_dwordx4 v10, s[24:27], s40 offen offset:0 sc1 lds
    buffer_load_dwordx4 v10, s[24:27], s40 offen offset:1024 sc1 lds
    buffer_load_dwordx4 v10, s[24:27], s40 offen offset:2048 sc1 lds
    buffer_load_dwordx4 v10, s[24:27], s40 offen offset:3072 sc1 lds
    s_add_u32 s40, s40, 32768
    s_and_b32 s40, s40, 0x3ffff
    s_cmp_eq_u32 s40, s47
    s_cselect_b32 s40, s50, s40
    s_add_u32 s43, s43, 32768
    s_and_b32 s43, s43, 0x1ffff
    buffer_store_dwordx4 v[64:67], v9, s[24:27], s48 offen offset:0 sc1
    buffer_store_dwordx4 v[68:71], v9, s[24:27], s48 offen offset:1024 sc1
    buffer_store_dwordx4 v[72:75], v9, s[24:27], s48 offen offset:2048 sc1
    buffer_store_dwordx4 v[76:79], v9, s[24:27], s48 offen offset:3072 sc1
    buffer_store_dwordx4 v[80:83], v10, s[24:27], s48 offen offset:0 sc1
    buffer_store_dwordx4 v[84:87], v10, s[24:27], s48 offen offset:1024 sc1
    buffer_store_dwordx4 v[88:91], v10, s[24:27], s48 offen offset:2048 sc1
    buffer_store_dwordx4 v[92:95], v10, s[24:27], s48 offen offset:3072 sc1
    s_waitcnt vmcnt(16)
    s_barrier
    s_add_u32 m0, s43, 0
    s_nop 0
    buffer_load_dwordx4 v9, s[24:27], s40 offen offset:0 sc1 lds
    buffer_load_dwordx4 v9, s[24:27], s40 offen offset:1024 sc1 lds
    buffer_load_dwordx4 v9, s[24:27], s40 offen offset:2048 sc1 lds
    buffer_load_dwordx4 v9, s[24:27], s40 offen offset:3072 sc1 lds
    s_add_u32 m0, s43, 4096
    s_nop 0
    buffer_load_dwordx4 v10, s[24:27], s40 offen offset:0 sc1 lds
    buffer_load_dwordx4 v10, s[24:27], s40 offen offset:1024 sc1 lds
    buffer_load_dwordx4 v10, s[24:27], s40 offen offset:2048 sc1 lds
    buffer_load_dwordx4 v10, s[24:27], s40 offen offset:3072 sc1 lds
    s_add_u32 s40, s40, 32768
    s_and_b32 s40, s40, 0x3ffff
    s_cmp_eq_u32 s40, s47
    s_cselect_b32 s40, s50, s40
    s_add_u32 s43, s43, 32768
    s_and_b32 s43, s43, 0x1ffff
    s_waitcnt vmcnt(8)
    s_mov_b64 exec, 1
    buffer_store_dword v23, v20, s[32:35], 0 offen sc1
    s_mov_b64 exec, -1
    s_barrier
    s_add_u32 m0, s43, 0
    s_nop 0
    buffer_load_dwordx4 v9, s[24:27], s40 offen offset:0 sc1 lds
    buffer_load_dwordx4 v9, s[24:27], s40 offen offset:1024 sc1 lds
    buffer_load_dwordx4 v9, s[24:27], s40 offen offset:2048 sc1 lds
    buffer_load_dwordx4 v9, s[24:27], s40 offen offset:3072 sc1 lds
    s_add_u32 m0, s43, 4096
    s_nop 0
    buffer_load_dwordx4 v10, s[24:27], s40 offen offset:0 sc1 lds
    buffer_load_dwordx4 v10, s[24:27], s40 offen offset:1024 sc1 lds
    buffer_load_dwordx4 v10, s[24:27], s40 offen offset:2048 sc1 lds
    buffer_load_dwordx4 v10, s[24:27], s40 offen offset:3072 sc1 lds
    s_add_u32 s40, s40, 32768
    s_and_b32 s40, s40, 0x3ffff
    s_cmp_eq_u32 s40, s47
    s_cselect_b32 s40, s50, s40
    s_add_u32 s43, s43, 32768
    s_and_b32 s43, s43, 0x1ffff
    s_mov_b32 s51, 9
    s_cmp_lt_u32 s21, 2
    s_cselect_b32 s54, 256, 0
    s_mov_b32 s55, 9
L_la_loop:
    s_waitcnt vmcnt(0)
    s_barrier
    s_cmp_lg_u32 s51, 3
    s_cbranch_scc1 L_nowpf
    s_mov_b32 s28, s52
    s_mov_b32 s29, s53
    s_mov_b32 s30, 2097152
    s_mov_b32 s31, 0x20000
    v_lshlrev_b32 v31, 7, v0
    s_lshl_b32 s19, s15, 16
    s_lshl_b32 s39, s21, 14
    s_add_u32 s19, s19, s39
    s_add_u32 s39, s19, 8192
    buffer_load_dword v32, v31, s[28:31], s19 offen
    buffer_load_dword v33, v31, s[28:31], s39 offen
L_nowpf:
L_la_again:
    s_cmp_eq_u32 s55, 0
    s_cbranch_scc1 L_la_none
    s_cmp_lg_u32 s55, 7
    s_cbranch_scc1 L_poll1c_x
    s_mov_b32 s46, 131072
    s_mov_b32 exec_lo, 0xff
    s_mov_b32 exec_hi, 0
L_poll1c:
    buffer_load_dword v27, v25, s[32:35], 0 offen sc1
    s_waitcnt vmcnt(0)
    v_cmp_gt_u32 vcc, 2, v27
    s_sub_u32 s46, s46, 1
    s_cbranch_scc1 L_poll1c_y
    s_cmp_eq_u64 vcc, 0
    s_cbranch_scc1 L_poll1c_y
    s_sleep 4
    s_branch L_poll1c
L_poll1c_y:
    s_mov_b64 exec, -1
L_poll1c_x:
    s_add_u32 m0, s43, 0
    s_nop 0
    buffer_load_dwordx4 v9, s[24:27], s40 offen offset:0 sc1 lds
    buffer_load_dwordx4 v9, s[24:27], s40 offen offset:1024 sc1 lds
    buffer_load_dwordx4 v9, s[24:27], s40 offen offset:2048 sc1 lds
    buffer_load_dwordx4 v9, s[24:27], s40 offen offset:3072 sc1 lds
    s_add_u32 m0, s43, 4096
    s_nop 0
    buffer_load_dwordx4 v10, s[24:27], s40 offen offset:0 sc1 lds
    buffer_load_dwordx4 v10, s[24:27], s40 offen offset:1024 sc1 lds
    buffer_load_dwordx4 v10, s[24:27], s40 offen offset:2048 sc1 lds
    buffer_load_dwordx4 v10, s[24:27], s40 offen offset:3072 sc1 lds
    s_add_u32 s40, s40, 32768
    s_and_b32 s40, s40, 0x3ffff
    s_cmp_eq_u32 s40, s47
    s_cselect_b32 s40, s50, s40
    s_add_u32 s43, s43, 32768
    s_and_b32 s43, s43, 0x1ffff
    s_sub_u32 s55, s55, 1
    s_bitcmp1_b32 s54, s51
    s_bitset0_b32 s54, s51
    s_cbranch_scc1 L_la_again
L_la_none:
    s_sub_u32 s51, s51, 1
    s_cmp_lg_u32 s51, 0
    s_cbranch_scc1 L_la_loop
    s_lshr_b32 s19, s15, 2
    s_lshl_b32 s19, s19, 8
    s_add_u32 s28, s52, s19
    s_addc_u32 s29, s53, 0
    s_sub_u32 s30, 2097152, s19
    s_mov_b32 s31, 0x20000
    s_lshl_b32 s19, s16, 6
    s_lshl_b32 s22, s38, 2
    s_add_u32 s19, s19, s22
    s_add_u32 s19, s19, s21
    s_lshl_b32 s19, s19, 16
    s_add_u32 s19, s19, 25165824
    s_add_u32 s24, s12, s19
    s_addc_u32 s25, s13, 0
    s_mov_b32 s26, 65536
    s_mov_b32 s27, 0x20000
    v_lshrrev_b32 v1, 3, v0
    v_and_b32 v2, 7, v0
    v_bfe_u32 v3, v0, 4, 1
    v_lshlrev_b32 v3, 1, v3
    v_xor_b32 v2, v2, v3
    s_lshr_b32 s19, s21, 1
    s_lshl_b32 s19, s19, 6
    s_and_b32 s39, s21, 1
    s_lshl_b32 s39, s39, 4
    s_add_u32 s19, s19, s39
    v_add_u32 v1, s19, v1
    v_lshlrev_b32 v1, 11, v1
    v_lshl_add_u32 v10, v2, 4, v1
    v_add_u32 v11, 16384, v10
    v_add_u32 v12, 128, v10
    v_add_u32 v13, 128, v11
    s_lshl_b32 s40, s49, 12
    s_lshl_b32 s41, s49, 17
    s_mov_b32 s47, s40
    s_mov_b32 s48, s41
    s_lshl_b32 s43, s21, 12
    s_add_u32 s43, s43, 131072
    s_lshl_b32 s44, s21, 11
    s_add_u32 s44, s44, 147456
    v_mov_b32 v34, 0
    s_add_u32 m0, s44, 0
    s_nop 0
    buffer_load_dwordx4 v10, s[28:31], s41 offen lds
    s_add_u32 m0, s44, 1024
    s_nop 0
    buffer_load_dwordx4 v11, s[28:31], s41 offen lds
    s_add_u32 m0, s44, 8192
    s_nop 0
    buffer_load_dwordx4 v12, s[28:31], s41 offen lds
    s_add_u32 m0, s44, 9216
    s_nop 0
    buffer_load_dwordx4 v13, s[28:31], s41 offen lds
    s_add_u32 s41, s41, 262144
    s_and_b32 s41, s41, 2097151
    s_cmp_eq_u32 s41, s48
    s_cselect_b32 s19, 65536, 0
    s_or_b32 s41, s41, s19
    s_add_u32 s44, s44, 32768
    s_sub_u32 s19, s44, 163840
    s_cmp_ge_u32 s44, 163840
    s_cselect_b32 s44, s19, s44
    s_waitcnt vmcnt(4)
    s_barrier
    s_add_u32 m0, s44, 0
    s_nop 0
    buffer_load_dwordx4 v10, s[28:31], s41 offen lds
    s_add_u32 m0, s44, 1024
    s_nop 0
    buffer_load_dwordx4 v11, s[28:31], s41 offen lds
    s_add_u32 m0, s44, 8192
    s_nop 0
    buffer_load_dwordx4 v12, s[28:31], s41 offen lds
    s_add_u32 m0, s44, 9216
    s_nop 0
    buffer_load_dwordx4 v13, s[28:31], s41 offen lds
    s_add_u32 s41, s41, 262144
    s_and_b32 s41, s41, 2097151
    s_cmp_eq_u32 s41, s48
    s_cselect_b32 s19, 65536, 0
    s_or_b32 s41, s41, s19
    s_add_u32 s44, s44, 32768
    s_sub_u32 s19, s44, 163840
    s_cmp_ge_u32 s44, 163840
    s_cselect_b32 s44, s19, s44
    s_mov_b32 s46, 131072
    s_mov_b32 exec_lo, 0xf
    s_mov_b32 exec_hi, 0
L_poll2:
    buffer_load_dword v34, v26, s[32:35], 0 offen sc1
    s_waitcnt vmcnt(0)
    v_cmp_gt_u32 vcc, 1, v34
    s_sub_u32 s46, s46, 1
    s_cbranch_scc1 L_poll2_y
    s_cmp_eq_u64 vcc, 0
    s_cbranch_scc1 L_poll2_y
    s_sleep 4
    s_branch L_poll2
L_poll2_y:
    s_mov_b64 exec, -1
L_poll2_x:
    s_mov_b64 exec, 0xfff0
    buffer_load_dword v34, v26, s[32:35], 0 offen sc1
    s_mov_b64 exec, -1
    s_mov_b32 m0, s43
    s_nop 0
    buffer_load_dwordx4 v8, s[24:27], s40 offen offset:0 sc1 lds
    buffer_load_dwordx4 v8, s[24:27], s40 offen offset:1024 sc1 lds
    buffer_load_dwordx4 v8, s[24:27], s40 offen offset:2048 sc1 lds
    buffer_load_dwordx4 v8, s[24:27], s40 offen offset:3072 sc1 lds
    s_add_u32 s40, s40, 8192
    s_and_b32 s40, s40, 0xffff
    s_cmp_eq_u32 s40, s47
    s_cselect_b32 s19, 4096, 0
    s_or_b32 s40, s40, s19
    s_add_u32 s43, s43, 32768
    s_sub_u32 s19, s43, 163840
    s_cmp_ge_u32 s43, 163840
    s_cselect_b32 s43, s19, s43
    s_mov_b32 m0, s43
    s_nop 0
    buffer_load_dwordx4 v8, s[24:27], s40 offen offset:0 sc1 lds
    buffer_load_dwordx4 v8, s[24:27], s40 offen offset:1024 sc1 lds
    buffer_load_dwordx4 v8, s[24:27], s40 offen offset:2048 sc1 lds
    buffer_load_dwordx4 v8, s[24:27], s40 offen offset:3072 sc1 lds
    s_add_u32 s40, s40, 8192
    s_and_b32 s40, s40, 0xffff
    s_cmp_eq_u32 s40, s47
    s_cselect_b32 s19, 4096, 0
    s_or_b32 s40, s40, s19
    s_add_u32 s43, s43, 32768
    s_sub_u32 s19, s43, 163840
    s_cmp_ge_u32 s43, 163840
    s_cselect_b32 s43, s19, s43
    s_mov_b32 s36, 0x30
    v_lshl_add_u32 v36, v0, 2, v21
    s_mov_b32 s46, 131072
    s_mov_b32 exec_lo, 0xf
    s_mov_b32 exec_hi, 0
L_poll4:
    buffer_load_dword v35, v36, s[32:35], 0 offen offset:16 sc1
    s_waitcnt vmcnt(0)
    v_cmp_gt_u32 vcc, 1, v35
    s_sub_u32 s46, s46, 1
    s_cbranch_scc1 L_poll4_y
    s_cmp_eq_u64 vcc, 0
    s_cbranch_scc1 L_poll4_y
    s_sleep 4
    s_branch L_poll4
L_poll4_y:
    s_mov_b64 exec, -1
L_poll4_x:
    v_cmp_gt_u32 vcc, 1, v34
    s_mul_i32 s37, s36, 0x55
    s_nop 0
    s_and_b32 s37, vcc_lo, s37
    s_cbranch_scc0 L_ens0_x
    s_and_b32 s19, s37, s36
    s_cbranch_scc0 L_ens0_a
    s_mov_b32 s46, 131072
    s_mov_b32 exec_lo, s36
    s_mov_b32 exec_hi, 0
L_ens0_p:
    buffer_load_dword v34, v26, s[32:35], 0 offen sc1
    s_waitcnt vmcnt(0)
    v_cmp_gt_u32 vcc, 1, v34
    s_sub_u32 s46, s46, 1
    s_cbranch_scc1 L_ens0_p_y
    s_cmp_eq_u64 vcc, 0
    s_cbranch_scc1 L_ens0_p_y
    s_sleep 4
    s_branch L_ens0_p
L_ens0_p_y:
    s_mov_b64 exec, -1
L_ens0_p_x:
L_ens0_a:
    s_mov_b32 exec_lo, s37
    s_mov_b32 exec_hi, 0
    buffer_load_dword v34, v26, s[32:35], 0 offen sc1
    s_mov_b64 exec, -1
L_ens0_x:
    s_lshl_b32 s36, s36, 2
    s_mov_b32 m0, s43
    s_nop 0
    buffer_load_dwordx4 v8, s[24:27], s40 offen offset:0 sc1 lds
    buffer_load_dwordx4 v8, s[24:27], s40 offen offset:1024 sc1 lds
    buffer_load_dwordx4 v8, s[24:27], s40 offen offset:2048 sc1 lds
    buffer_load_dwordx4 v8, s[24:27], s40 offen offset:3072 sc1 lds
    s_add_u32 s40, s40, 8192
    s_and_b32 s40, s40, 0xffff
    s_cmp_eq_u32 s40, s47
    s_cselect_b32 s19, 4096, 0
    s_or_b32 s40, s40, s19
    s_add_u32 s43, s43, 32768
    s_sub_u32 s19, s43, 163840
    s_cmp_ge_u32 s43, 163840
    s_cselect_b32 s43, s19, s43
    v_cmp_gt_u32 vcc, 1, v34
    s_mul_i32 s37, s36, 0x55
    s_nop 0
    s_and_b32 s37, vcc_lo, s37
    s_cbranch_scc0 L_ens1_x
    s_and_b32 s19, s37, s36
    s_cbranch_scc0 L_ens1_a
    s_mov_b32 s46, 131072
    s_mov_b32 exec_lo, s36
    s_mov_b32 exec_hi, 0
L_ens1_p:
    buffer_load_dword v34, v26, s[32:35], 0 offen sc1
    s_waitcnt vmcnt(0)
    v_cmp_gt_u32 vcc, 1, v34
    s_sub_u32 s46, s46, 1
    s_cbranch_scc1 L_ens1_p_y
    s_cmp_eq_u64 vcc, 0
    s_cbranch_scc1 L_ens1_p_y
    s_sleep 4
    s_branch L_ens1_p
L_ens1_p_y:
    s_mov_b64 exec, -1
L_ens1_p_x:
L_ens1_a:
    s_mov_b32 exec_lo, s37
    s_mov_b32 exec_hi, 0
    buffer_load_dword v34, v26, s[32:35], 0 offen sc1
    s_mov_b64 exec, -1
L_ens1_x:
    s_lshl_b32 s36, s36, 2
    s_mov_b32 m0, s43
    s_nop 0
    buffer_load_dwordx4 v8, s[24:27], s40 offen offset:0 sc1 lds
    buffer_load_dwordx4 v8, s[24:27], s40 offen offset:1024 sc1 lds
    buffer_load_dwordx4 v8, s[24:27], s40 offen offset:2048 sc1 lds
    buffer_load_dwordx4 v8, s[24:27], s40 offen offset:3072 sc1 lds
    s_add_u32 s40, s40, 8192
    s_and_b32 s40, s40, 0xffff
    s_cmp_eq_u32 s40, s47
    s_cselect_b32 s19, 4096, 0
    s_or_b32 s40, s40, s19
    s_add_u32 s43, s43, 32768
    s_sub_u32 s19, s43, 163840
    s_cmp_ge_u32 s43, 163840
    s_cselect_b32 s43, s19, s43
    v_cmp_gt_u32 vcc, 1, v34
    s_mul_i32 s37, s36, 0x55
    s_nop 0
    s_and_b32 s37, vcc_lo, s37
    s_cbranch_scc0 L_ens2_x
    s_and_b32 s19, s37, s36
    s_cbranch_scc0 L_ens2_a
    s_mov_b32 s46, 131072
    s_mov_b32 exec_lo, s36
    s_mov_b32 exec_hi, 0
L_ens2_p:
    buffer_load_dword v34, v26, s[32:35], 0 offen sc1
    s_waitcnt vmcnt(0)
    v_cmp_gt_u32 vcc, 1, v34
    s_sub_u32 s46, s46, 1
    s_cbranch_scc1 L_ens2_p_y
    s_cmp_eq_u64 vcc, 0
    s_cbranch_scc1 L_ens2_p_y
    s_sleep 4
    s_branch L_ens2_p
L_ens2_p_y:
    s_mov_b64 exec, -1
L_ens2_p_x:
L_ens2_a:
    s_mov_b32 exec_lo, s37
    s_mov_b32 exec_hi, 0
    buffer_load_dword v34, v26, s[32:35], 0 offen sc1
    s_mov_b64 exec, -1
L_ens2_x:
    s_lshl_b32 s36, s36, 2
    s_mov_b32 m0, s43
    s_nop 0
    buffer_load_dwordx4 v8, s[24:27], s40 offen offset:0 sc1 lds
    buffer_load_dwordx4 v8, s[24:27], s40 offen offset:1024 sc1 lds
    buffer_load_dwordx4 v8, s[24:27], s40 offen offset:2048 sc1 lds
    buffer_load_dwordx4 v8, s[24:27], s40 offen offset:3072 sc1 lds
    s_add_u32 s40, s40, 8192
    s_and_b32 s40, s40, 0xffff
    s_cmp_eq_u32 s40, s47
    s_cselect_b32 s19, 4096, 0
    s_or_b32 s40, s40, s19
    s_add_u32 s43, s43, 32768
    s_sub_u32 s19, s43, 163840
    s_cmp_ge_u32 s43, 163840
    s_cselect_b32 s43, s19, s43
    s_barrier
    s_barrier
    s_mov_b32 s53, 2
    s_mov_b32 s51, 2
    s_mov_b32 s50, 14
L_lo_loop:
    s_cmp_eq_u32 s53, 3
    s_cbranch_scc1 L_lo_w3
    s_cmp_ge_i32 s51, 0
    s_cbranch_scc1 L_lo_have
    v_cmp_gt_u32 vcc, 1, v34
    s_mul_i32 s37, s36, 0x55
    s_nop 0
    s_and_b32 s37, vcc_lo, s37
    s_cbranch_scc0 L_ens3_x
    s_and_b32 s19, s37, s36
    s_cbranch_scc0 L_ens3_a
    s_mov_b32 s46, 131072
    s_mov_b32 exec_lo, s36
    s_mov_b32 exec_hi, 0
L_ens3_p:
    buffer_load_dword v34, v26, s[32:35], 0 offen sc1
    s_waitcnt vmcnt(0)
    v_cmp_gt_u32 vcc, 1, v34
    s_sub_u32 s46, s46, 1
    s_cbranch_scc1 L_ens3_p_y
    s_cmp_eq_u64 vcc, 0
    s_cbranch_scc1 L_ens3_p_y
    s_sleep 4
    s_branch L_ens3_p
L_ens3_p_y:
    s_mov_b64 exec, -1
L_ens3_p_x:
L_ens3_a:
    s_mov_b32 exec_lo, s37
    s_mov_b32 exec_hi, 0
    buffer_load_dword v34, v26, s[32:35], 0 offen sc1
    s_mov_b64 exec, -1
L_ens3_x:
    s_lshl_b32 s36, s36, 2
    s_mov_b32 m0, s43
    s_nop 0
    buffer_load_dwordx4 v8, s[24:27], s40 offen offset:0 sc1 lds
    buffer_load_dwordx4 v8, s[24:27], s40 offen offset:1024 sc1 lds
    buffer_load_dwordx4 v8, s[24:27], s40 offen offset:2048 sc1 lds
    buffer_load_dwordx4 v8, s[24:27], s40 offen offset:3072 sc1 lds
    s_add_u32 s40, s40, 8192
    s_and_b32 s40, s40, 0xffff
    s_cmp_eq_u32 s40, s47
    s_cselect_b32 s19, 4096, 0
    s_or_b32 s40, s40, s19
    s_add_u32 s43, s43, 32768
    s_sub_u32 s19, s43, 163840
    s_cmp_ge_u32 s43, 163840
    s_cselect_b32 s43, s19, s43
    s_mov_b32 s51, 0
L_lo_have:
    s_cmp_eq_u32 s51, 2
    s_cbranch_scc1 L_lo_w2
    s_cmp_eq_u32 s51, 1
    s_cbranch_scc1 L_lo_w1
    s_waitcnt vmcnt(0)
L_lo_w1:
    s_waitcnt vmcnt(4)
L_lo_w2:
    s_waitcnt vmcnt(8)
L_lo_w3:
    s_barrier
    s_mov_b32 s53, 2
    s_sub_u32 s51, s51, 1
    s_cmp_ge_i32 s51, 2
    s_cbranch_scc1 L_lo_next
L_lo_try:
    s_cmp_eq_u32 s36, 0
    s_cbranch_scc1 L_lo_next
    v_cmp_gt_u32 vcc, 1, v34
    s_mul_i32 s37, s36, 0x55
    s_nop 0
    s_and_b32 s37, vcc_lo, s37
    s_and_b32 s19, s37, s36
    s_cbranch_scc1 L_lo_ref
    s_lshl_b32 s36, s36, 2
    s_mov_b32 m0, s43
    s_nop 0
    buffer_load_dwordx4 v8, s[24:27], s40 offen offset:0 sc1 lds
    buffer_load_dwordx4 v8, s[24:27], s40 offen offset:1024 sc1 lds
    buffer_load_dwordx4 v8, s[24:27], s40 offen offset:2048 sc1 lds
    buffer_load_dwordx4 v8, s[24:27], s40 offen offset:3072 sc1 lds
    s_add_u32 s40, s40, 8192
    s_and_b32 s40, s40, 0xffff
    s_cmp_eq_u32 s40, s47
    s_cselect_b32 s19, 4096, 0
    s_or_b32 s40, s40, s19
    s_add_u32 s43, s43, 32768
    s_sub_u32 s19, s43, 163840
    s_cmp_ge_u32 s43, 163840
    s_cselect_b32 s43, s19, s43
    s_add_u32 s51, s51, 1
    s_cmp_lt_i32 s51, s53
    s_cbranch_scc1 L_lo_try
    s_cmp_eq_u32 s37, 0
    s_cbranch_scc1 L_lo_next
L_lo_ref:
    s_mov_b32 exec_lo, s37
    s_mov_b32 exec_hi, 0
    buffer_load_dword v34, v26, s[32:35], 0 offen sc1
    s_mov_b64 exec, -1
L_lo_next:
    s_sub_u32 s50, s50, 1
    s_cmp_lg_u32 s50, 0
    s_cbranch_scc1 L_lo_loop
L_end:
    s_endpgm
.section .rodata,"a"
.p2align 6
.amdhsa_kernel concat_heads__softmax_full_mha__mha_block__prompt_kernel
  .amdhsa_next_free_vgpr 168
  .amdhsa_next_free_sgpr 100
  .amdhsa_accum_offset 168
  .amdhsa_group_segment_fixed_size 0
  .amdhsa_kernarg_size 72
  .amdhsa_user_sgpr_count 2
  .amdhsa_user_sgpr_kernarg_segment_ptr 1
  .amdhsa_system_sgpr_workgroup_id_x 1
.end_amdhsa_kernel
```
